```python
import torch

def _softmax(x, axis=-1):
    return torch.softmax(x, dim=axis)
def _gelu(x):
    return torch.nn.functional.gelu(x, approximate="tanh")
def _silu(x):
    return torch.nn.functional.silu(x)
def _sigmoid(x):
    return torch.sigmoid(x)
def _layernorm(x, axis=-1, eps=1e-5):
    m = x.mean(dim=axis, keepdim=True)
    v = x.var(dim=axis, keepdim=True, unbiased=False)
    return (x - m) / torch.sqrt(v + eps)
def _scatter_add(tgt, idx, src, axis=0):
    return tgt.clone().index_add_(axis, idx, src)
def _segment_sum(src, seg, n):
    out = torch.zeros((n,) + src.shape[1:], dtype=src.dtype)
    return out.index_add_(0, seg, src)
def _pad(x, pw):
    flat = tuple(v for pair in reversed(pw) for v in pair)
    return torch.nn.functional.pad(x, flat)

kernel_name = 'recurrent_scan__sliding_local_dilated__dense_activation_gelu__prompt'

def setup_inputs():

    _w = (lambda a: (lambda t: t.to(torch.bfloat16) if t.is_floating_point() else t)(torch.as_tensor(a)))
    def _A_setup():
        B, S, D = 1, 2048, 512
        return {
            "x": _w((lambda *s: torch.randn(*s, dtype=torch.bfloat16) * 0.05)(B, S, D)),
            "wqkv": _w((lambda *s: torch.randn(*s, dtype=torch.bfloat16) * 0.2)(D, 3 * D)),
            "wo": _w((lambda *s: torch.randn(*s, dtype=torch.bfloat16) * 0.2)(D, D)),
        }
    _A_in = _A_setup()

    def _B_setup():
        B, S, D, F = 1, 2048, 512, 1792
        return {
            "x": _w((lambda *s: torch.randn(*s, dtype=torch.bfloat16) * 0.05)(B, S, D)),
            "w1": _w((lambda *s: torch.randn(*s, dtype=torch.bfloat16) * 0.4)(D, F) * (D ** -0.5)),
            "b1": _w((lambda *s: torch.randn(*s, dtype=torch.bfloat16) * 0.4)(F) * 0.01),
            "w2": _w((lambda *s: torch.randn(*s, dtype=torch.bfloat16) * 0.1)(F, D) * (F ** -0.5)),
            "b2": _w((lambda *s: torch.randn(*s, dtype=torch.bfloat16) * 0.1)(D) * 0.01),
        }
    _B_in = _B_setup()

    return {
        "A_x": _A_in["x"],
        "A_wqkv": _A_in["wqkv"],
        "A_wo": _A_in["wo"],
        "B_x": _B_in["x"],
        "B_w1": _B_in["w1"],
        "B_b1": _B_in["b1"],
        "B_w2": _B_in["w2"],
        "B_b2": _B_in["b2"],
    }

def reference(A_x, A_wqkv, A_wo, B_x, B_w1, B_b1, B_w2, B_b2):
    def _A_ref(x, wqkv, wo):
        B, S, D = x.shape
        H = 32; Dh = D // H
        W, dil = 8, 2
        qkv = (lambda x, *d: x.permute(*d))((x @ wqkv).reshape(B, S, 3, H, Dh), 2, 0, 3, 1, 4)
        q, k, v = qkv[0], qkv[1], qkv[2]
        scale = Dh ** -0.5
        pos = torch.arange(S)
        off = torch.arange(W) * dil
        idx = pos[:, None] - off[None, :]
        mask = idx >= 0
        idx_c = torch.where(mask, idx, 0).reshape(-1)
        kg = k[:, :, idx_c, :].reshape(B, H, S, W, Dh)
        vg = v[:, :, idx_c, :].reshape(B, H, S, W, Dh)
        logits = torch.einsum("bhsd,bhswd->bhsw", q, kg) * scale
        logits = torch.where(mask[None, None, :, :], logits, -1e9)
        attn = _softmax(logits, axis=-1)
        o = torch.einsum("bhsw,bhswd->bhsd", attn, vg)
        return (lambda x, *d: x.permute(*d))(o, 0, 2, 1, 3).reshape(B, S, D) @ wo

    def _B_ref(x, w1, b1, w2, b2):
        h = torch.einsum("bsd,df->bsf", x, w1) + b1
        h = _gelu(h)
        return torch.einsum("bsf,fd->bsd", h, w2) + b2

    x = A_x
    xn = _layernorm(x, axis=-1)
    s = _A_ref(xn, A_wqkv, A_wo)
    g = _silu(_B_ref(xn, B_w1, B_b1, B_w2, B_b2))
    return x + s * g
```

```asm
; @launch grid=(256,1,1) block=(256,1,1) lds=163840
.amdgcn_target "amdgcn-amd-amdhsa--gfx950"
.text
.p2align 12
.globl recurrent_scan__sliding_local_dilated__dense_activation_gelu__prompt_kernel
.p2align 8
.type recurrent_scan__sliding_local_dilated__dense_activation_gelu__prompt_kernel,@function
recurrent_scan__sliding_local_dilated__dense_activation_gelu__prompt_kernel:
    s_cmp_ge_u32 s2, 256
    s_cbranch_scc1 L_end
    s_load_dwordx16 s[4:19], s[0:1], 0
    s_load_dwordx4 s[20:23], s[0:1], 64
    s_load_dwordx2 s[24:25], s[0:1], 80
    v_lshrrev_b32 v1, 6, v0
    v_and_b32 v255, 63, v0
    v_readfirstlane_b32 s82, v1
    s_lshr_b32 s54, s2, 3
    s_getpc_b64 s[26:27]
    v_lshrrev_b32_e64 v2, 4, v0
    v_lshl_add_u32 v2, s54, 4, v2
    v_min_u32 v2, 0x17a, v2
    v_lshlrev_b32 v2, 7, v2
    v_mov_b32 v3, s27
    v_add_co_u32 v2, vcc, s26, v2
    s_nop 1
    v_addc_co_u32 v3, vcc, 0, v3, vcc
    global_load_dword v243, v[2:3], off
    v_lshrrev_b32 v2, 3, v255
    v_and_b32 v3, 7, v255
    v_lshrrev_b32 v4, 4, v255
    s_and_b32 s87, s2, 7
    s_lshr_b32 s83, s87, 2
    s_lshl_b32 s83, s83, 3
    s_and_b32 s89, s54, 7
    s_add_u32 s83, s83, s89
    s_and_b32 s84, s87, 3
    s_lshl_b32 s84, s84, 1
    s_bfe_u32 s89, s54, 0x10003
    s_add_u32 s84, s84, s89
    v_xor_b32 v5, v3, v4
    v_lshlrev_b32 v5, 4, v5
    v_lshl_add_u32 v5, v2, 11, v5
    s_lshl_b32 s3, s83, 17
    s_lshl_b32 s89, s82, 15
    s_add_u32 s89, s89, s3
    s_add_u32 s89, s89, 4096
    v_add_u32 v229, s89, v5
    v_xor_b32_e64 v5, 64, v229
    v_add_u32 v230, 15360, v5
    v_add_u32 v231, -1024, v229
    v_add_u32 v232, 14336, v5
    s_mul_i32 s96, s82, 11264
    s_mov_b32 s51, 0
    s_mov_b32 s52, 0
    v_lshlrev_b32 v254, 4, v255
    s_lshl_b32 s56, s2, 2
    s_add_u32 s56, s56, s82
    s_waitcnt lgkmcnt(0)
    s_sub_u32 s28, s4, 4096
    s_subb_u32 s29, s5, 0
    s_mov_b32 s30, 2101248
    s_mov_b32 s31, 0x20000
    s_bitcmp1_b32 s2, 7
    s_cbranch_scc0 L_pro_at
    s_add_u32 m0, s96, 0
    s_nop 0
    buffer_load_dwordx4 v229, s[28:31], s51 offen offset:0 lds
    buffer_load_dwordx4 v230, s[28:31], s51 offen offset:1024 lds
    buffer_load_dwordx4 v231, s[28:31], s51 offen offset:2048 lds
    buffer_load_dwordx4 v232, s[28:31], s51 offen offset:3072 lds
    v_and_b32 v7, 3, v255
    v_lshlrev_b32 v7, 4, v7
    v_lshrrev_b32 v5, 2, v255
    v_mul_u32_u24 v6, 3584, v5
    v_and_b32 v5, 7, v5
    v_mul_u32_u24 v5, 3584, v5
    v_and_b32 v20, 32, v255
    v_lshl_add_u32 v5, v20, 1, v5
    s_mul_i32 s89, s82, 57344
    s_mul_i32 s3, s84, 448
    s_add_u32 s89, s89, s3
    s_add_u32 s89, s89, 4096
    s_bitcmp1_b32 s84, 0
    s_cselect_b32 s3, 0, 384
    s_cselect_b32 s87, 64, 0
    s_add_u32 s3, s3, s89
    s_add_u32 s89, s89, s87
    v_xor_b32 v20, v20, v7
    v_add3_u32 v233, v20, v6, s3
    v_add3_u32 v7, v7, v5, s89
    v_xor_b32_e64 v6, 32, v7
    v_add_u32 v234, -1024, v7
    v_add_u32 v235, 26624, v6
    v_add_u32 v236, -2944, v7
    v_add_u32 v237, 28800, v6
    v_add_u32 v238, -768, v7
    v_add_u32 v239, 26880, v6
    s_mov_b32 s50, 229376
    s_sub_u32 s32, s12, 4096
    s_subb_u32 s33, s13, 0
    s_mov_b32 s34, 1839104
    s_mov_b32 s35, 0x20000
    s_add_u32 m0, s96, 4096
    s_nop 0
    buffer_load_dwordx4 v233, s[32:35], s52 offen offset:0 lds
    buffer_load_dwordx4 v234, s[32:35], s52 offen offset:1024 lds
    buffer_load_dwordx4 v235, s[32:35], s52 offen offset:2048 lds
    buffer_load_dwordx4 v236, s[32:35], s52 offen offset:3072 lds
    s_add_u32 m0, s96, 8192
    s_nop 0
    buffer_load_dwordx4 v237, s[32:35], s52 offen offset:0 lds
    buffer_load_dwordx4 v238, s[32:35], s52 offen offset:1024 lds
    buffer_load_dwordx4 v239, s[32:35], s52 offen offset:2048 lds
    s_addk_i32 s51, 128
    s_add_u32 s52, s52, s50
    s_mov_b32 s36, s24
    s_mov_b32 s37, s25
    s_mov_b32 s38, 37748736
    s_mov_b32 s39, 0x20000
    s_branch L_pro_join
L_pro_at:
    s_mov_b32 s36, s24
    s_mov_b32 s37, s25
    s_mov_b32 s38, 37748736
    s_mov_b32 s39, 0x20000
    s_and_b32 s87, s83, 3
    s_lshl_b32 s87, s87, 2
    s_add_u32 s87, s87, s82
    s_lshl_b32 s57, s82, 12
    v_and_b32 v8, 1, v4
    v_lshlrev_b32 v8, 1, v8
    v_xor_b32 v8, v3, v8
    v_lshlrev_b32 v8, 4, v8
    s_lshl_b32 s88, s84, 2
    s_lshr_b32 s55, 0x64531207, s88
    s_and_b32 s55, s55, 7
    s_lshl_b32 s55, s55, 4
    s_add_u32 s55, s55, s83
    s_lshr_b32 s88, s55, 2
    s_lshl_b32 s88, s88, 7
    v_mul_u32_u24 v16, 3584, v2
    v_add_u32 v16, v8, v16
    v_xor_b32 v19, 64, v16
    v_add_u32 v17, 27648, v19
    v_add_u32 v18, 55296, v16
    v_add_u32 v19, 82944, v19
    s_mul_i32 s89, s87, 114688
    s_add_u32 s89, s89, s88
    s_add_u32 m0, s57, 135168
    s_mov_b32 s40, s12
    s_mov_b32 s41, s13
    s_cmp_lt_u32 s55, 112
    s_cselect_b32 s42, 1835008, 0
    s_mov_b32 s43, 0x20000
    buffer_load_dwordx4 v16, s[40:43], s89 offen offset:0 lds
    buffer_load_dwordx4 v17, s[40:43], s89 offen offset:1024 lds
    buffer_load_dwordx4 v18, s[40:43], s89 offen offset:2048 lds
    buffer_load_dwordx4 v19, s[40:43], s89 offen offset:3072 lds
    v_and_b32 v1, 0xf0, v254
    v_lshl_add_u32 v1, v4, 10, v1
    s_lshl_b32 s89, s56, 12
    s_add_u32 s89, s89, 4096
    buffer_load_dwordx4 v[64:67], v1, s[28:31], s89 offen offset:0
    buffer_load_dwordx4 v[68:71], v1, s[28:31], s89 offen offset:256
    buffer_load_dwordx4 v[72:75], v1, s[28:31], s89 offen offset:512
    buffer_load_dwordx4 v[76:79], v1, s[28:31], s89 offen offset:768
    s_lshl_b32 s88, s84, 2
    s_lshr_b32 s97, 0x54367201, s88
    s_and_b32 s97, s97, 7
    s_lshl_b32 s97, s97, 4
    s_add_u32 s97, s97, s83
    s_lshr_b32 s88, s97, 2
    s_lshl_b32 s88, s88, 7
    v_mul_u32_u24 v16, 3072, v2
    v_add_u32 v16, v8, v16
    v_xor_b32 v19, 64, v16
    v_add_u32 v17, 23552, v19
    v_add_u32 v18, 47104, v16
    v_add_u32 v19, 70656, v19
    s_mul_i32 s89, s87, 98304
    s_add_u32 s89, s89, s88
    s_add_u32 m0, s57, 90112
    s_mov_b32 s40, s6
    s_mov_b32 s41, s7
    s_cmp_lt_u32 s97, 96
    s_cselect_b32 s42, 1572864, 0
    s_mov_b32 s43, 0x20000
    buffer_load_dwordx4 v16, s[40:43], s89 offen offset:0 lds
    buffer_load_dwordx4 v17, s[40:43], s89 offen offset:1024 lds
    buffer_load_dwordx4 v18, s[40:43], s89 offen offset:2048 lds
    buffer_load_dwordx4 v19, s[40:43], s89 offen offset:3072 lds
    s_lshl_b32 s89, s82, 2
    v_add_u32 v7, s89, v2
    v_and_b32 v5, 7, v7
    v_bfe_u32 v6, v7, 3, 1
    v_lshl_add_u32 v5, v5, 1, v6
    v_bfe_u32 v6, v7, 1, 3
    v_xor_b32 v6, v3, v6
    v_lshlrev_b32 v6, 4, v6
    v_lshl_add_u32 v5, v5, 10, v6
    s_sub_u32 s3, s3, 12288
    s_cselect_b32 s3, 1073741824, s3
    v_add_u32_e64 v233, s3, v5
    s_mov_b32 s80, 0
    v_mul_u32_u24 v6, 3072, v2
    s_mul_i32 s89, s82, 49152
    s_lshl_b32 s3, s84, 7
    s_add_u32 s89, s89, s3
    v_add3_u32 v7, v8, v6, s89
    v_xor_b32_e64 v6, 64, v7
    v_add_u32 v234, 3072, v7
    v_add_u32 v235, 26624, v6
    v_add_u32 v236, 2048, v7
    v_add_u32 v237, 29696, v6
    v_add_u32 v238, 5120, v7
    v_add_u32 v239, 28672, v6
    s_mov_b32 s50, 196608
    s_sub_u32 s32, s6, 4096
    s_subb_u32 s33, s7, 0
    s_mov_b32 s34, 1576960
    s_mov_b32 s35, 0x20000
L_pro_join:
    s_mov_b32 s68, s4
    s_mov_b32 s69, s5
    s_mov_b32 s70, 2097152
    s_mov_b32 s71, 0x20000
    s_mov_b32 s44, s22
    s_mov_b32 s45, s23
    s_mov_b32 s46, 256
    s_mov_b32 s47, 0x20000
    s_mov_b32 s79, 0x20000
    v_mov_b32 v240, 1
    s_and_b32 s89, s2, 6
    s_lshl_b32 s85, s89, 2
    s_and_b32 s89, s54, 7
    s_add_u32 s85, s85, s89
    s_lshr_b32 s86, s54, 3
    s_xor_b32 s86, s86, 3
    s_and_b32 s89, s2, 1
    s_lshl_b32 s89, s89, 2
    s_add_u32 s86, s86, s89
    v_and_b32 v5, 3, v255
    v_lshrrev_b32_e64 v6, 5, v255
    v_bfe_u32 v20, v255, 4, 1
    v_bfe_u32 v7, v255, 2, 2
    v_lshlrev_b32 v21, 1, v20
    v_xor_b32 v21, v21, v5
    v_lshlrev_b32_e64 v21, 4, v21
    v_lshl_add_u32 v21, v6, 6, v21
    v_lshl_add_u32 v21, v7, 10, v21
    s_lshl_b32 s49, s86, 7
    v_add_u32 v21, s49, v21
    v_lshl_add_u32 v218, v20, 12, v21
    v_add_u32 v219, 7168, v218
    v_lshl_add_u32 v220, v20, 13, v21
    v_add_u32 v221, 15360, v220
    v_lshlrev_b32_e64 v21, 3, v5
    v_lshl_add_u32 v21, v7, 6, v21
    v_mul_u32_u24 v23, 288, v20
    v_lshl_add_u32 v23, v6, 10, v23
    v_add_u32 v21, v21, v23
    v_add_u32 v222, s96, v21
    v_xor_b32_e64 v223, 32, v222
    v_add_u32 v224, 90112, v222
    v_add_u32 v225, 90112, v223
    s_lshl_b32 s58, s82, 12
    s_add_u32 s58, s58, 143360
    v_add_u32 v226, s58, v21
    v_xor_b32 v227, 32, v226
    s_lshl_b32 s89, s82, 17
    s_sub_u32 s66, 524288, s89
    s_add_u32 s64, s8, s89
    s_addc_u32 s65, s9, 0
    s_mov_b32 s67, 0x20000
    s_mul_i32 s89, s82, 458752
    s_sub_u32 s62, 1835008, s89
    s_add_u32 s60, s16, s89
    s_addc_u32 s61, s17, 0
    s_mov_b32 s63, 0x20000
    v_lshlrev_b32 v228, 2, v255
    v_lshlrev_b32 v242, 7, v6
    v_lshl_or_b32 v248, v6, 30, v228
    v_lshlrev_b32_e64 v21, 4, v3
    v_lshl_add_u32 v247, v2, 11, v21
    v_add_u32 v249, 15360, v247
    v_lshrrev_b32 v250, 3, v255
    v_lshlrev_b32 v250, 7, v250
    v_lshlrev_b32 v251, 7, v4
    s_lshr_b32 s89, s82, 1
    s_lshl_b32 s43, s85, 1
    s_add_u32 s43, s43, s89
    s_lshl_b32 s43, s43, 5
    s_and_b32 s89, s82, 1
    s_add_u32 s43, s43, s89
    s_lshl_b32 s43, s43, 10
    s_add_u32 s43, s43, s49
    s_lshr_b32 s48, s85, 1
    s_lshl_b32 s48, s48, 2
    s_add_u32 s48, s48, s82
    s_lshl_b32 s48, s48, 10
    s_add_u32 s48, s48, 10551296
    s_lshl_b32 s42, s85, 2
    s_add_u32 s42, s42, s82
    s_lshl_b32 s42, s42, 9
    s_add_u32 s42, s42, 10616832
    s_mul_i32 s41, s85, 294912
    s_add_u32 s41, s41, 16777216
    s_mov_b32 s40, s41
    s_mul_i32 s89, s82, 57344
    s_add_u32 s41, s41, s89
    s_add_u32 s41, s41, 65536
    s_add_u32 s89, s54, 0
    s_and_b32 s89, s89, 3
    s_mul_i32 s0, s89, 12288
    s_add_u32 s0, s0, s41
    s_and_b32 s3, s89, 1
    s_lshl_b32 s3, s3, 15
    s_lshr_b32 s89, s89, 1
    s_lshl_b32 s89, s89, 18
    s_add_u32 s59, s89, s3
    s_add_u32 s89, s54, 1
    s_and_b32 s89, s89, 3
    s_mul_i32 s1, s89, 12288
    s_add_u32 s1, s1, s41
    s_and_b32 s3, s89, 1
    s_lshl_b32 s3, s3, 15
    s_lshr_b32 s89, s89, 1
    s_lshl_b32 s89, s89, 18
    s_add_u32 s81, s89, s3
    s_add_u32 s89, s54, 2
    s_and_b32 s89, s89, 3
    s_mul_i32 s10, s89, 12288
    s_add_u32 s10, s10, s41
    s_and_b32 s3, s89, 1
    s_lshl_b32 s3, s3, 15
    s_lshr_b32 s89, s89, 1
    s_lshl_b32 s89, s89, 18
    s_add_u32 s94, s89, s3
    s_add_u32 s89, s54, 3
    s_and_b32 s89, s89, 3
    s_mul_i32 s11, s89, 12288
    s_add_u32 s11, s11, s41
    s_and_b32 s3, s89, 1
    s_lshl_b32 s3, s3, 15
    s_lshr_b32 s89, s89, 1
    s_lshl_b32 s89, s89, 18
    s_add_u32 s95, s89, s3
    s_lshr_b32 s89, s54, 0
    s_and_b32 s89, s89, 3
    s_lshl_b32 s57, s89, 15
    s_and_b32 s93, s57, 0x8000
    s_lshl_b32 s89, s89, 12
    s_add_u32 s40, s40, s89
    s_and_b32 s89, s89, 4096
    s_add_u32 s41, s41, s89
    s_add_u32 s41, s41, 49152
    s_mov_b32 s72, s20
    s_mov_b32 s73, s21
    s_mov_b32 s74, 2097152
    s_mov_b32 s75, 0x20000
    s_bitcmp1_b32 s2, 7
    s_cbranch_scc1 L_ffn
    s_branch R_at
.p2alignl 12, 0xbf810000
.fill 368, 4, 0xbf810000
R_at:
    s_andn2_b32 s87, s55, 3
    s_add_u32 s87, s87, s82
    s_lshl_b32 s87, s87, 5
    s_movk_i32 s78, 3584
    s_mov_b32 s76, s14
    s_mov_b32 s77, s15
    v_subrev_u32 v23, 48, v255
    v_lshlrev_b32_e64 v23, 1, v23
    v_min_u32 v23, 1073741824, v23
    buffer_load_ushort v190, v23, s[76:79], s87 offen
    v_bfe_u32 v7, v255, 2, 2
    v_lshl_add_u32 v188, v4, 3, v7
    v_lshlrev_b32_e64 v188, 7, v188
    v_lshl_add_u32 v188, v5, 3, v188
    v_bfe_u32 v7, v255, 3, 2
    v_xor_b32_e64 v7, s82, v7
    v_lshl_add_u32 v188, v7, 5, v188
    v_add_u32 v188, 90112, v188
    v_mov_b32 v22, 1073741824
    v_cmp_eq_u32 vcc, 0, v0
    v_mov_b32 v192, 0x3f803f80
    v_mov_b32 v193, v192
    v_cndmask_b32 v253, v22, v0, vcc
    v_mov_b32 v194, v192
    v_mov_b32 v195, v192
    v_and_b32 v30, 15, v255
    s_lshl_b32 s89, s82, 6
    v_lshl_add_u32 v31, v30, 2, s89
    s_lshl_b32 s89, s97, 8
    s_add_u32 s3, s89, 9502720
    v_add_u32 v23, s3, v31
    s_mov_b32 s90, 0xffff0000
    s_mov_b32 s91, 0
    v_cndmask_b32 v189, v22, v23, s[90:91]
    s_lshr_b32 s3, s55, 2
    s_add_u32 s3, s3, s55
    s_lshl_b32 s3, s3, 8
    s_add_u32 s3, s3, 9568256
    v_add_u32_e64 v23, s3, v31
    v_lshl_add_u32 v23, v6, 10, v23
    s_mov_b32 s90, 0xffff
    s_and_b32 s88, s83, 3
    s_cselect_b32 s91, 0, 0xffff0000
    v_cndmask_b32 v189, v189, v23, s[90:91]
    s_lshl_b32 s89, s56, 7
    s_add_u32 s89, s89, 10551296
    v_writelane_b32 v189, s89, 32
    s_add_u32 s89, s89, 0x10000
    v_writelane_b32 v189, s89, 33
    s_add_u32 s89, s89, 0x20000
    v_writelane_b32 v189, s89, 34
    s_lshl_b32 s89, s56, 5
    s_add_u32 s89, s89, 9437184
    v_cmp_gt_u32 vcc, 2, v30
    v_lshl_add_u32 v23, v4, 1, v30
    v_lshl_add_u32 v23, v23, 2, s89
    v_cndmask_b32 v191, v22, v23, vcc
    s_lshl_b32 s88, s84, 2
    s_lshr_b32 s88, 0x432ff10f, s88
    s_and_b32 s88, s88, 15
    s_lshl_b32 s88, s88, 4
    s_add_u32 s88, s88, s83
    s_lshl_b32 s88, s88, 2
    s_add_u32 s88, s88, s82
    s_mul_i32 s89, s88, 45
    s_mul_i32 s88, s88, 13
    v_min_u32 v252, 44, v255
    v_add_lshl_u32 v252, v252, s89, 7
    v_min_u32 v245, 12, v255
    v_add_lshl_u32 v245, v245, s88, 7
    v_lshrrev_b32 v7, 1, v30
    v_xor_b32 v7, v4, v7
    v_lshl_add_u32 v126, v4, 8, v31
    v_mov_b32 v197, 0
    v_mov_b32 v199, 0
    v_mov_b32 v201, 0
    v_lshlrev_b32 v7, 4, v7
    v_lshl_add_u32 v108, v30, 7, v7
    v_xor_b32 v109, 64, v108
    v_add_u32 v110, 45056, v108
    v_add_u32 v111, 45056, v109
    v_add_u32 v112, 90112, v108
    v_add_u32 v113, 90112, v109
    v_lshrrev_b32 v5, 2, v30
    v_mul_u32_u24 v6, 11264, v5
    v_and_b32 v31, 3, v30
    v_lshl_add_u32 v6, v31, 7, v6
    v_add_u32 v114, v6, v7
    v_xor_b32 v115, 64, v114
    v_add_u32 v116, 90112, v114
    v_add_u32 v117, 90112, v115
    v_lshrrev_b32 v7, 1, v4
    v_and_b32 v6, 1, v4
    s_and_b32 s87, s82, 1
    s_lshl_b32 s87, s87, 5
    v_lshl_add_u32 v20, v7, 4, v30
    v_add_lshl_u32 v20, v20, s87, 4
    v_mov_b32_e64 v123, v20
    v_lshl_add_u32 v123, v6, 10, v123
    v_mul_u32_u24 v7, 11264, v7
    v_lshl_add_u32 v7, v6, 10, v7
    v_lshl_add_u32 v7, v5, 7, v7
    v_lshl_add_u32 v7, v31, 3, v7
    v_lshrrev_b32 v20, 1, v5
    v_lshl_or_b32 v20, v6, 1, v20
    v_xor_b32 v20, s82, v20
    v_lshl_add_u32 v118, v20, 5, v7
    v_add_u32 v119, 45056, v118
    v_add_u32 v120, 90112, v118
    v_lshlrev_b32 v121, 2, v30
    v_add_u32 v121, 159744, v121
    v_and_b32 v122, 48, v255
    v_add_u32 v122, 159744, v122
    v_min_u32 v20, 143, v0
    v_and_b32_e64 v23, 15, v20
    v_bfe_u32 v52, v20, 4, 1
    v_lshl_add_u32 v23, v23, 1, v52
    v_and_b32 v52, 0x60, v20
    v_add_u32 v23, v23, v52
    v_and_b32 v52, 7, v20
    v_bfe_u32 v53, v20, 3, 1
    v_lshl_add_u32 v52, v52, 1, v53
    v_subrev_u32 v52, 16, v52
    v_cmp_le_u32 vcc, 128, v20
    s_lshl_b32 s87, s83, 7
    v_mov_b32 v148, v192
    v_cndmask_b32 v20, v23, v52, vcc
    v_add_u32 v20, s87, v20
    v_max_i32 v20, 0, v20
    v_lshlrev_b32 v125, 3, v20
    v_mov_b32 v149, v192
    v_lshlrev_b32 v7, 2, v4
    v_sub_u32 v7, v30, v7
    v_mov_b32 v52, 0xf149f2ca
    s_cmp_eq_u32 s83, 0
    s_cselect_b32 s87, 0xf149f2ca, 0
    v_mov_b32 v53, s87
    v_cmp_le_u32 vcc, 2, v4
    v_mov_b32 v54, 0
    s_mov_b32 s87, 0xffff
    v_cndmask_b32 v55, v53, v52, vcc
    v_subrev_u32 v6, 0, v7
    v_cmp_ge_u32 vcc, 7, v6
    v_cmp_ge_i32 s[90:91], -9, v6
    v_ashrrev_i32 v56, 31, v6
    v_cndmask_b32 v128, v52, v54, vcc
    v_cndmask_b32 v132, v52, v54, s[90:91]
    v_cndmask_b32 v140, v52, v53, s[90:91]
    v_bfi_b32 v136, v56, v55, v52
    v_subrev_u32 v6, 1, v7
    v_cmp_ge_u32 vcc, 7, v6
    v_cmp_ge_i32 s[90:91], -9, v6
    v_ashrrev_i32 v57, 31, v6
    v_cndmask_b32 v129, v52, v54, vcc
    v_cndmask_b32 v133, v52, v54, s[90:91]
    v_cndmask_b32 v141, v52, v53, s[90:91]
    v_bfi_b32 v137, v57, v55, v52
    v_subrev_u32 v6, 2, v7
    v_cmp_ge_u32 vcc, 7, v6
    v_cmp_ge_i32 s[90:91], -9, v6
    v_ashrrev_i32 v58, 31, v6
    v_cndmask_b32 v130, v52, v54, vcc
    v_cndmask_b32 v134, v52, v54, s[90:91]
    v_cndmask_b32 v142, v52, v53, s[90:91]
    v_bfi_b32 v138, v58, v55, v52
    v_subrev_u32 v6, 3, v7
    v_cmp_ge_u32 vcc, 7, v6
    v_cmp_ge_i32 s[90:91], -9, v6
    v_ashrrev_i32 v59, 31, v6
    v_cndmask_b32 v131, v52, v54, vcc
    v_cndmask_b32 v135, v52, v54, s[90:91]
    v_cndmask_b32 v143, v52, v53, s[90:91]
    v_bfi_b32 v139, v59, v55, v52
    v_bfi_b32 v146, s87, v56, v57
    v_bfi_b32 v147, s87, v58, v59
    v_not_b32 v144, v146
    v_not_b32 v145, v147
    s_lshl_b32 s87, s84, 2
    s_add_u32 s87, s87, s82
    s_mul_i32 s97, s83, 144
    s_lshr_b32 s88, s87, 1
    s_add_u32 s97, s97, s88
    s_lshl_b32 s97, s97, 12
    s_add_u32 s97, s97, 16777216
    s_lshl_b32 s99, s84, 10
    s_add_u32 s99, s99, 9502720
    s_lshl_b32 s98, s83, 5
    s_add_u32 s98, s98, s87
    s_lshl_b32 s98, s98, 7
    s_add_u32 s98, s98, 10551296
    s_add_u32 m0, s96, 0
    s_nop 0
    buffer_load_dwordx4 v229, s[28:31], s51 offen offset:0 lds
    buffer_load_dwordx4 v230, s[28:31], s51 offen offset:1024 lds
    buffer_load_dwordx4 v231, s[28:31], s51 offen offset:2048 lds
    buffer_load_dwordx4 v232, s[28:31], s51 offen offset:3072 lds
    s_add_u32 m0, s96, 4096
    s_mov_b32 exec_hi, s80
    buffer_load_dwordx4 v233, s[28:31], s51 offen offset:0 lds
    s_mov_b32 exec_hi, -1
    buffer_load_dwordx4 v234, s[32:35], s52 offen offset:1024 lds
    buffer_load_dwordx4 v235, s[32:35], s52 offen offset:2048 lds
    buffer_load_dwordx4 v236, s[32:35], s52 offen offset:3072 lds
    s_add_u32 m0, s96, 8192
    s_nop 0
    buffer_load_dwordx4 v237, s[32:35], s52 offen offset:0 lds
    buffer_load_dwordx4 v238, s[32:35], s52 offen offset:1024 lds
    buffer_load_dwordx4 v239, s[32:35], s52 offen offset:2048 lds
    s_addk_i32 s51, 128
    s_add_u32 s52, s52, s50
    s_waitcnt vmcnt(11)
    s_barrier
    ds_read_b64_tr_b16 a[0:1], v188 offset:45056
    ds_read_b64_tr_b16 a[2:3], v188 offset:45568
    ds_read_b64_tr_b16 a[4:5], v188 offset:49152
    ds_read_b64_tr_b16 a[6:7], v188 offset:49664
    ds_read_b64_tr_b16 a[8:9], v188 offset:53248
    ds_read_b64_tr_b16 a[10:11], v188 offset:53760
    ds_read_b64_tr_b16 a[12:13], v188 offset:57344
    ds_read_b64_tr_b16 a[14:15], v188 offset:57856
    ds_read_b64_tr_b16 a[16:17], v188 offset:0
    ds_read_b64_tr_b16 a[18:19], v188 offset:512
    ds_read_b64_tr_b16 a[20:21], v188 offset:4096
    ds_read_b64_tr_b16 a[22:23], v188 offset:4608
    ds_read_b64_tr_b16 a[24:25], v188 offset:8192
    ds_read_b64_tr_b16 a[26:27], v188 offset:8704
    ds_read_b64_tr_b16 a[28:29], v188 offset:12288
    ds_read_b64_tr_b16 a[30:31], v188 offset:12800
    v_dot2_f32_bf16 v80, v64, v192, 0
    v_dot2_f32_bf16 v81, v64, v64, 0
    v_dot2_f32_bf16 v80, v65, v192, v80
    v_dot2_f32_bf16 v81, v65, v65, v81
    v_dot2_f32_bf16 v80, v66, v192, v80
    v_dot2_f32_bf16 v81, v66, v66, v81
    v_dot2_f32_bf16 v80, v67, v192, v80
    v_dot2_f32_bf16 v81, v67, v67, v81
    v_dot2_f32_bf16 v80, v68, v192, v80
    v_dot2_f32_bf16 v81, v68, v68, v81
    v_dot2_f32_bf16 v80, v69, v192, v80
    v_dot2_f32_bf16 v81, v69, v69, v81
    v_dot2_f32_bf16 v80, v70, v192, v80
    v_dot2_f32_bf16 v81, v70, v70, v81
    v_dot2_f32_bf16 v80, v71, v192, v80
    v_dot2_f32_bf16 v81, v71, v71, v81
    v_dot2_f32_bf16 v80, v72, v192, v80
    v_dot2_f32_bf16 v81, v72, v72, v81
    v_dot2_f32_bf16 v80, v73, v192, v80
    v_dot2_f32_bf16 v81, v73, v73, v81
    v_dot2_f32_bf16 v80, v74, v192, v80
    v_dot2_f32_bf16 v81, v74, v74, v81
    v_dot2_f32_bf16 v80, v75, v192, v80
    v_dot2_f32_bf16 v81, v75, v75, v81
    v_dot2_f32_bf16 v80, v76, v192, v80
    v_dot2_f32_bf16 v81, v76, v76, v81
    v_dot2_f32_bf16 v80, v77, v192, v80
    v_dot2_f32_bf16 v81, v77, v77, v81
    v_dot2_f32_bf16 v80, v78, v192, v80
    v_dot2_f32_bf16 v81, v78, v78, v81
    v_dot2_f32_bf16 v80, v79, v192, v80
    v_dot2_f32_bf16 v81, v79, v79, v81
    s_waitcnt lgkmcnt(14)
    v_mfma_f32_16x16x32_bf16 v[84:87], v[192:195], a[0:3], 0
    s_waitcnt lgkmcnt(6)
    v_add_f32_dpp v80, v80, v80 row_ror:8 row_mask:0xf bank_mask:0xf
    v_mfma_f32_16x16x32_bf16 v[88:91], v[192:195], a[16:19], 0
    v_add_f32_dpp v81, v81, v81 row_ror:8 row_mask:0xf bank_mask:0xf
    v_mfma_f32_16x16x32_bf16 v[84:87], v[192:195], a[4:7], v[84:87]
    s_waitcnt lgkmcnt(4)
    v_add_f32_dpp v80, v80, v80 row_ror:4 row_mask:0xf bank_mask:0xf
    v_mfma_f32_16x16x32_bf16 v[88:91], v[192:195], a[20:23], v[88:91]
    v_add_f32_dpp v81, v81, v81 row_ror:4 row_mask:0xf bank_mask:0xf
    v_mfma_f32_16x16x32_bf16 v[84:87], v[192:195], a[8:11], v[84:87]
    s_waitcnt lgkmcnt(2)
    v_add_f32_dpp v80, v80, v80 row_ror:2 row_mask:0xf bank_mask:0xf
    v_mfma_f32_16x16x32_bf16 v[88:91], v[192:195], a[24:27], v[88:91]
    v_add_f32_dpp v81, v81, v81 row_ror:2 row_mask:0xf bank_mask:0xf
    v_mfma_f32_16x16x32_bf16 v[84:87], v[192:195], a[12:15], v[84:87]
    s_waitcnt lgkmcnt(0)
    v_add_f32_dpp v80, v80, v80 row_ror:1 row_mask:0xf bank_mask:0xf
    v_mfma_f32_16x16x32_bf16 v[88:91], v[192:195], a[28:31], v[88:91]
    v_add_f32_dpp v81, v81, v81 row_ror:1 row_mask:0xf bank_mask:0xf
    s_add_u32 m0, s96, 45056
    s_nop 0
    buffer_load_dwordx4 v229, s[28:31], s51 offen offset:0 lds
    buffer_load_dwordx4 v230, s[28:31], s51 offen offset:1024 lds
    v_mul_f32 v80, 0x3b000000, v80
    v_mul_f32 v81, 0x3b000000, v81
    v_fma_f32 v81, -v80, v80, v81
    v_max_f32 v81, 0, v81
    v_cvt_pk_bf16_f32 v82, 0, v81
    v_add_f32 v82, 0x3727c5ac, v82
    v_cvt_pk_bf16_f32 v82, 0, v82
    v_sqrt_f32_e64 v82, v82
    v_cvt_pk_bf16_f32 v80, 0, -v80
    v_cvt_pk_bf16_f32 v82, 0, v82
    v_rcp_f32 v82, v82
    v_and_b32 v81, 1, v255
    v_cmp_eq_u32 vcc, 0, v81
    s_mov_b32 s90, 0xffff
    s_mov_b32 s91, 0
    v_cndmask_b32 v80, v82, v80, vcc
    v_cndmask_b32 v84, v88, v84, s[90:91]
    v_cmp_gt_u32 vcc, 32, v255
    v_and_b32 v85, 0xffff0000, v84
    v_sub_f32_e64 v85, v84, v85
    s_mov_b32 s89, 0x07060302
    v_perm_b32 v84, v85, v84, s89
    v_cndmask_b32 v190, v190, v84, vcc
    v_mov_b32 v187, v80
    buffer_store_dword v187, v191, s[36:39], 0 offen sc1
    buffer_store_dword v190, v189, s[36:39], 0 offen sc1
    buffer_load_dwordx4 v231, s[28:31], s51 offen offset:2048 lds
    buffer_load_dwordx4 v232, s[28:31], s51 offen offset:3072 lds
    s_add_u32 m0, s96, 49152
    s_mov_b32 exec_hi, s80
    buffer_load_dwordx4 v233, s[28:31], s51 offen offset:0 lds
    s_mov_b32 exec_hi, -1
    buffer_load_dwordx4 v234, s[32:35], s52 offen offset:1024 lds
    s_waitcnt vmcnt(8)
    s_barrier
    ds_read_b64_tr_b16 a[136:137], v118 offset:5120
    ds_read_b64_tr_b16 a[138:139], v118 offset:5632
    ds_read_b64_tr_b16 a[148:149], v118 offset:27648
    ds_read_b64_tr_b16 a[150:151], v118 offset:28160
    ds_read_b64_tr_b16 a[140:141], v118 offset:7168
    ds_read_b64_tr_b16 a[142:143], v118 offset:7680
    ds_read_b64_tr_b16 a[152:153], v118 offset:29696
    ds_read_b64_tr_b16 a[154:155], v118 offset:30208
    ds_read_b64_tr_b16 a[144:145], v118 offset:9216
    ds_read_b64_tr_b16 a[146:147], v118 offset:9728
    ds_read_b64_tr_b16 a[156:157], v118 offset:31744
    ds_read_b64_tr_b16 a[158:159], v118 offset:32256
    ds_read_b128 a[184:187], v108 offset:0
    ds_read_b128 a[188:191], v109 offset:0
    ds_read_b128 a[192:195], v108 offset:2048
    ds_read_b128 a[196:199], v109 offset:2048
    ds_read_b128 a[200:203], v108 offset:11264
    ds_read_b128 a[204:207], v109 offset:11264
    ds_read_b128 a[208:211], v108 offset:13312
    ds_read_b128 a[212:215], v109 offset:13312
    buffer_load_dwordx4 v235, s[32:35], s52 offen offset:2048 lds
    buffer_load_dwordx4 v236, s[32:35], s52 offen offset:3072 lds
    s_add_u32 m0, s96, 53248
    s_nop 0
    buffer_load_dwordx4 v237, s[32:35], s52 offen offset:0 lds
    buffer_load_dwordx4 v238, s[32:35], s52 offen offset:1024 lds
    s_waitcnt lgkmcnt(4)
    v_mfma_f32_16x16x32_bf16 v[0:3], a[136:139], a[184:187], 0
    ds_read_b128 a[216:219], v108 offset:22528
    v_mfma_f32_16x16x32_bf16 v[0:3], a[148:151], a[188:191], v[0:3]
    buffer_load_dwordx4 v239, s[32:35], s52 offen offset:2048 lds
    v_mfma_f32_16x16x32_bf16 v[36:39], a[152:155], a[188:191], 0
    ds_read_b128 a[220:223], v109 offset:22528
    v_mfma_f32_16x16x32_bf16 v[36:39], a[140:143], a[184:187], v[36:39]
    s_addk_i32 s51, 128
    v_mfma_f32_16x16x32_bf16 v[72:75], a[184:187], a[144:147], 0
    ds_read_b128 a[224:227], v108 offset:24576
    s_add_u32 s52, s52, s50
    v_mfma_f32_16x16x32_bf16 v[72:75], a[188:191], a[156:159], v[72:75]
    ds_read_b128 a[228:231], v109 offset:24576
    v_mfma_f32_16x16x32_bf16 v[4:7], a[136:139], a[192:195], 0
    ds_read_b128 a[232:235], v108 offset:33792
    s_add_u32 m0, s96, 90112
    v_mfma_f32_16x16x32_bf16 v[4:7], a[148:151], a[196:199], v[4:7]
    buffer_load_dwordx4 v229, s[28:31], s51 offen offset:0 lds
    v_mfma_f32_16x16x32_bf16 v[40:43], a[152:155], a[196:199], 0
    ds_read_b128 a[236:239], v109 offset:33792
    v_mfma_f32_16x16x32_bf16 v[40:43], a[140:143], a[192:195], v[40:43]
    buffer_load_dwordx4 v230, s[28:31], s51 offen offset:1024 lds
    v_mfma_f32_16x16x32_bf16 v[76:79], a[192:195], a[144:147], 0
    ds_read_b128 a[240:243], v108 offset:35840
    v_mfma_f32_16x16x32_bf16 v[76:79], a[196:199], a[156:159], v[76:79]
    ds_read_b128 a[244:247], v109 offset:35840
    s_waitcnt lgkmcnt(8)
    v_mfma_f32_16x16x32_bf16 v[8:11], a[136:139], a[200:203], 0
    ds_read_b128 a[248:251], v114 offset:4096
    v_mfma_f32_16x16x32_bf16 v[8:11], a[148:151], a[204:207], v[8:11]
    ds_read_b128 a[252:255], v115 offset:4096
    v_mfma_f32_16x16x32_bf16 v[44:47], a[152:155], a[204:207], 0
    buffer_load_dwordx4 v231, s[28:31], s51 offen offset:2048 lds
    v_mfma_f32_16x16x32_bf16 v[44:47], a[140:143], a[200:203], v[44:47]
    buffer_load_dwordx4 v232, s[28:31], s51 offen offset:3072 lds
    v_mfma_f32_16x16x32_bf16 v[80:83], a[200:203], a[144:147], 0
    s_add_u32 m0, s96, 94208
    v_mfma_f32_16x16x32_bf16 v[80:83], a[204:207], a[156:159], v[80:83]
    s_mov_b32 exec_hi, s80
    buffer_load_dwordx4 v233, s[28:31], s51 offen offset:0 lds
    s_mov_b32 exec_hi, -1
    v_mfma_f32_16x16x32_bf16 v[12:15], a[136:139], a[208:211], 0
    buffer_load_dwordx4 v234, s[32:35], s52 offen offset:1024 lds
    v_mfma_f32_16x16x32_bf16 v[12:15], a[148:151], a[212:215], v[12:15]
    buffer_load_dwordx4 v235, s[32:35], s52 offen offset:2048 lds
    v_mfma_f32_16x16x32_bf16 v[48:51], a[152:155], a[212:215], 0
    buffer_load_dwordx4 v236, s[32:35], s52 offen offset:3072 lds
    v_mfma_f32_16x16x32_bf16 v[48:51], a[140:143], a[208:211], v[48:51]
    v_mfma_f32_16x16x32_bf16 v[84:87], a[208:211], a[144:147], 0
    v_mfma_f32_16x16x32_bf16 v[84:87], a[212:215], a[156:159], v[84:87]
M_at:
    s_waitcnt vmcnt(8) lgkmcnt(0)
    s_barrier
    v_mfma_f32_16x16x32_bf16 v[16:19], a[136:139], a[216:219], 0
    ds_read_b64_tr_b16 a[160:161], v119 offset:5120
    s_and_b32 s87, s2, 1
    v_mfma_f32_16x16x32_bf16 v[16:19], a[148:151], a[220:223], v[16:19]
    s_lshl_b32 s87, s87, 7
    v_mfma_f32_16x16x32_bf16 v[52:55], a[152:155], a[220:223], 0
    buffer_atomic_add v240, v253, s[44:47], s87 offen sc1
    v_mfma_f32_16x16x32_bf16 v[52:55], a[140:143], a[216:219], v[52:55]
    ds_read_b64_tr_b16 a[162:163], v119 offset:5632
    v_mfma_f32_16x16x32_bf16 v[88:91], a[216:219], a[144:147], 0
    ds_read_b64_tr_b16 a[172:173], v119 offset:27648
    s_add_u32 m0, s96, 98304
    v_mfma_f32_16x16x32_bf16 v[88:91], a[220:223], a[156:159], v[88:91]
    ds_read_b64_tr_b16 a[174:175], v119 offset:28160
    v_mfma_f32_16x16x32_bf16 v[20:23], a[136:139], a[224:227], 0
    buffer_load_dwordx4 v237, s[32:35], s52 offen offset:0 lds
    v_mfma_f32_16x16x32_bf16 v[20:23], a[148:151], a[228:231], v[20:23]
    ds_read_b64_tr_b16 a[164:165], v119 offset:7168
    v_mfma_f32_16x16x32_bf16 v[56:59], a[152:155], a[228:231], 0
    ds_read_b64_tr_b16 a[166:167], v119 offset:7680
    buffer_load_dwordx4 v238, s[32:35], s52 offen offset:1024 lds
    v_mfma_f32_16x16x32_bf16 v[56:59], a[140:143], a[224:227], v[56:59]
    ds_read_b64_tr_b16 a[176:177], v119 offset:29696
    v_mfma_f32_16x16x32_bf16 v[92:95], a[224:227], a[144:147], 0
    ds_read_b64_tr_b16 a[178:179], v119 offset:30208
    v_mfma_f32_16x16x32_bf16 v[92:95], a[228:231], a[156:159], v[92:95]
    buffer_load_dwordx4 v239, s[32:35], s52 offen offset:2048 lds
    v_mfma_f32_16x16x32_bf16 v[24:27], a[136:139], a[232:235], 0
    ds_read_b64_tr_b16 a[168:169], v119 offset:9216
    s_addk_i32 s51, 128
    v_mfma_f32_16x16x32_bf16 v[24:27], a[148:151], a[236:239], v[24:27]
    ds_read_b64_tr_b16 a[170:171], v119 offset:9728
    s_add_u32 s52, s52, s50
    v_mfma_f32_16x16x32_bf16 v[60:63], a[152:155], a[236:239], 0
    ds_read_b64_tr_b16 a[180:181], v119 offset:31744
    v_mfma_f32_16x16x32_bf16 v[60:63], a[140:143], a[232:235], v[60:63]
    ds_read_b64_tr_b16 a[182:183], v119 offset:32256
    s_add_u32 m0, s96, 0
    v_mfma_f32_16x16x32_bf16 v[96:99], a[232:235], a[144:147], 0
    ds_read_b128 a[184:187], v110 offset:0
    v_mfma_f32_16x16x32_bf16 v[96:99], a[236:239], a[156:159], v[96:99]
    buffer_load_dwordx4 v229, s[28:31], s51 offen offset:0 lds
    v_mfma_f32_16x16x32_bf16 v[28:31], a[136:139], a[240:243], 0
    ds_read_b128 a[188:191], v111 offset:0
    v_mfma_f32_16x16x32_bf16 v[28:31], a[148:151], a[244:247], v[28:31]
    buffer_load_dwordx4 v230, s[28:31], s51 offen offset:1024 lds
    v_mfma_f32_16x16x32_bf16 v[64:67], a[152:155], a[244:247], 0
    ds_read_b128 a[192:195], v110 offset:2048
    v_mfma_f32_16x16x32_bf16 v[64:67], a[140:143], a[240:243], v[64:67]
    ds_read_b128 a[196:199], v111 offset:2048
    v_mfma_f32_16x16x32_bf16 v[100:103], a[240:243], a[144:147], 0
    buffer_load_dwordx4 v231, s[28:31], s51 offen offset:2048 lds
    v_mfma_f32_16x16x32_bf16 v[100:103], a[244:247], a[156:159], v[100:103]
    ds_read_b128 a[200:203], v110 offset:11264
    v_mfma_f32_16x16x32_bf16 v[68:71], a[152:155], a[252:255], 0
    ds_read_b128 a[204:207], v111 offset:11264
    v_mfma_f32_16x16x32_bf16 v[68:71], a[140:143], a[248:251], v[68:71]
    ds_read_b128 a[208:211], v110 offset:13312
    v_mfma_f32_16x16x32_bf16 v[104:107], a[248:251], a[144:147], 0
    buffer_load_dwordx4 v232, s[28:31], s51 offen offset:3072 lds
    v_mfma_f32_16x16x32_bf16 v[104:107], a[252:255], a[156:159], v[104:107]
    ds_read_b128 a[212:215], v111 offset:13312
    s_waitcnt lgkmcnt(4)
    v_mfma_f32_16x16x32_bf16 v[0:3], a[160:163], a[184:187], v[0:3]
    ds_read_b128 a[216:219], v110 offset:22528
    v_mfma_f32_16x16x32_bf16 v[0:3], a[172:175], a[188:191], v[0:3]
    ds_read_b128 a[220:223], v111 offset:22528
    v_mfma_f32_16x16x32_bf16 v[36:39], a[176:179], a[188:191], v[36:39]
    ds_read_b128 a[224:227], v110 offset:24576
    v_mfma_f32_16x16x32_bf16 v[36:39], a[164:167], a[184:187], v[36:39]
    s_add_u32 m0, s96, 4096
    v_mfma_f32_16x16x32_bf16 v[72:75], a[184:187], a[168:171], v[72:75]
    ds_read_b128 a[228:231], v111 offset:24576
    v_mfma_f32_16x16x32_bf16 v[72:75], a[188:191], a[180:183], v[72:75]
    s_mov_b32 exec_hi, s80
    buffer_load_dwordx4 v233, s[28:31], s51 offen offset:0 lds
    s_mov_b32 exec_hi, -1
    v_mfma_f32_16x16x32_bf16 v[4:7], a[160:163], a[192:195], v[4:7]
    v_mfma_f32_16x16x32_bf16 v[4:7], a[172:175], a[196:199], v[4:7]
    ds_read_b128 a[232:235], v110 offset:33792
    v_mfma_f32_16x16x32_bf16 v[40:43], a[176:179], a[196:199], v[40:43]
    ds_read_b128 a[236:239], v111 offset:33792
    v_mfma_f32_16x16x32_bf16 v[40:43], a[164:167], a[192:195], v[40:43]
    buffer_load_dwordx4 v234, s[32:35], s52 offen offset:1024 lds
    v_mfma_f32_16x16x32_bf16 v[76:79], a[192:195], a[168:171], v[76:79]
    v_mfma_f32_16x16x32_bf16 v[76:79], a[196:199], a[180:183], v[76:79]
    ds_read_b128 a[240:243], v110 offset:35840
    s_waitcnt lgkmcnt(7)
    v_mfma_f32_16x16x32_bf16 v[8:11], a[160:163], a[200:203], v[8:11]
    ds_read_b128 a[244:247], v111 offset:35840
    v_mfma_f32_16x16x32_bf16 v[8:11], a[172:175], a[204:207], v[8:11]
    buffer_load_dwordx4 v235, s[32:35], s52 offen offset:2048 lds
    v_mfma_f32_16x16x32_bf16 v[44:47], a[176:179], a[204:207], v[44:47]
    ds_read_b128 a[248:251], v114 offset:49152
    v_mfma_f32_16x16x32_bf16 v[44:47], a[164:167], a[200:203], v[44:47]
    buffer_load_dwordx4 v236, s[32:35], s52 offen offset:3072 lds
    v_mfma_f32_16x16x32_bf16 v[80:83], a[200:203], a[168:171], v[80:83]
    v_mfma_f32_16x16x32_bf16 v[80:83], a[204:207], a[180:183], v[80:83]
    ds_read_b128 a[252:255], v115 offset:49152
    s_add_u32 m0, s96, 8192
    v_mfma_f32_16x16x32_bf16 v[12:15], a[160:163], a[208:211], v[12:15]
    buffer_load_dwordx4 v237, s[32:35], s52 offen offset:0 lds
    v_mfma_f32_16x16x32_bf16 v[12:15], a[172:175], a[212:215], v[12:15]
    buffer_load_dwordx4 v238, s[32:35], s52 offen offset:1024 lds
    v_mfma_f32_16x16x32_bf16 v[48:51], a[176:179], a[212:215], v[48:51]
    buffer_load_dwordx4 v239, s[32:35], s52 offen offset:2048 lds
    v_mfma_f32_16x16x32_bf16 v[48:51], a[164:167], a[208:211], v[48:51]
    v_mfma_f32_16x16x32_bf16 v[84:87], a[208:211], a[168:171], v[84:87]
    v_mfma_f32_16x16x32_bf16 v[84:87], a[212:215], a[180:183], v[84:87]
    s_addk_i32 s51, 128
    s_add_u32 s52, s52, s50
    s_waitcnt vmcnt(11) lgkmcnt(0)
    s_barrier
    v_mfma_f32_16x16x32_bf16 v[16:19], a[160:163], a[216:219], v[16:19]
    ds_read_b64_tr_b16 a[136:137], v120 offset:5120
    v_mfma_f32_16x16x32_bf16 v[16:19], a[172:175], a[220:223], v[16:19]
    ds_read_b64_tr_b16 a[138:139], v120 offset:5632
    s_add_u32 m0, s96, 45056
    v_mfma_f32_16x16x32_bf16 v[52:55], a[176:179], a[220:223], v[52:55]
    ds_read_b64_tr_b16 a[148:149], v120 offset:27648
    v_mfma_f32_16x16x32_bf16 v[52:55], a[164:167], a[216:219], v[52:55]
    buffer_load_dwordx4 v229, s[28:31], s51 offen offset:0 lds
    v_mfma_f32_16x16x32_bf16 v[88:91], a[216:219], a[168:171], v[88:91]
    v_mfma_f32_16x16x32_bf16 v[88:91], a[220:223], a[180:183], v[88:91]
    ds_read_b64_tr_b16 a[150:151], v120 offset:28160
    v_mfma_f32_16x16x32_bf16 v[20:23], a[160:163], a[224:227], v[20:23]
    ds_read_b64_tr_b16 a[140:141], v120 offset:7168
    v_mfma_f32_16x16x32_bf16 v[20:23], a[172:175], a[228:231], v[20:23]
    ds_read_b64_tr_b16 a[142:143], v120 offset:7680
    v_mfma_f32_16x16x32_bf16 v[56:59], a[176:179], a[228:231], v[56:59]
    buffer_load_dwordx4 v230, s[28:31], s51 offen offset:1024 lds
    v_mfma_f32_16x16x32_bf16 v[56:59], a[164:167], a[224:227], v[56:59]
    ds_read_b64_tr_b16 a[152:153], v120 offset:29696
    v_mfma_f32_16x16x32_bf16 v[92:95], a[224:227], a[168:171], v[92:95]
    ds_read_b64_tr_b16 a[154:155], v120 offset:30208
    v_mfma_f32_16x16x32_bf16 v[92:95], a[228:231], a[180:183], v[92:95]
    buffer_load_dwordx4 v231, s[28:31], s51 offen offset:2048 lds
    v_mfma_f32_16x16x32_bf16 v[24:27], a[160:163], a[232:235], v[24:27]
    ds_read_b64_tr_b16 a[144:145], v120 offset:9216
    v_mfma_f32_16x16x32_bf16 v[24:27], a[172:175], a[236:239], v[24:27]
    ds_read_b64_tr_b16 a[146:147], v120 offset:9728
    v_mfma_f32_16x16x32_bf16 v[60:63], a[176:179], a[236:239], v[60:63]
    s_mov_b32 s76, s16
    s_mov_b32 s77, s17
    s_mov_b32 s78, 1835008
    v_mfma_f32_16x16x32_bf16 v[60:63], a[164:167], a[232:235], v[60:63]
    ds_read_b64_tr_b16 a[156:157], v120 offset:31744
    v_mfma_f32_16x16x32_bf16 v[96:99], a[232:235], a[168:171], v[96:99]
    ds_read_b64_tr_b16 a[158:159], v120 offset:32256
    v_mfma_f32_16x16x32_bf16 v[96:99], a[236:239], a[180:183], v[96:99]
    ds_read_b128 a[184:187], v112 offset:0
    v_mfma_f32_16x16x32_bf16 v[28:31], a[160:163], a[240:243], v[28:31]
    ds_read_b128 a[188:191], v113 offset:0
    v_mfma_f32_16x16x32_bf16 v[28:31], a[172:175], a[244:247], v[28:31]
    buffer_load_dwordx4 v232, s[28:31], s51 offen offset:3072 lds
    v_mfma_f32_16x16x32_bf16 v[64:67], a[176:179], a[244:247], v[64:67]
    ds_read_b128 a[192:195], v112 offset:2048
    v_mfma_f32_16x16x32_bf16 v[64:67], a[164:167], a[240:243], v[64:67]
    ds_read_b128 a[196:199], v113 offset:2048
    v_mfma_f32_16x16x32_bf16 v[100:103], a[240:243], a[168:171], v[100:103]
    ds_read_b128 a[200:203], v112 offset:11264
    v_mfma_f32_16x16x32_bf16 v[100:103], a[244:247], a[180:183], v[100:103]
    ds_read_b128 a[204:207], v113 offset:11264
    s_add_u32 m0, s96, 49152
    v_mfma_f32_16x16x32_bf16 v[68:71], a[176:179], a[252:255], v[68:71]
    ds_read_b128 a[208:211], v112 offset:13312
    v_mfma_f32_16x16x32_bf16 v[68:71], a[164:167], a[248:251], v[68:71]
    s_mov_b32 exec_hi, s80
    buffer_load_dwordx4 v233, s[28:31], s51 offen offset:0 lds
    s_mov_b32 exec_hi, -1
    v_mfma_f32_16x16x32_bf16 v[104:107], a[248:251], a[168:171], v[104:107]
    v_mfma_f32_16x16x32_bf16 v[104:107], a[252:255], a[180:183], v[104:107]
    ds_read_b128 a[212:215], v113 offset:13312
    s_waitcnt lgkmcnt(4)
    v_mfma_f32_16x16x32_bf16 v[0:3], a[136:139], a[184:187], v[0:3]
    ds_read_b128 a[216:219], v112 offset:22528
    v_mfma_f32_16x16x32_bf16 v[0:3], a[148:151], a[188:191], v[0:3]
    buffer_load_dwordx4 v234, s[32:35], s52 offen offset:1024 lds
    v_mfma_f32_16x16x32_bf16 v[36:39], a[152:155], a[188:191], v[36:39]
    v_mfma_f32_16x16x32_bf16 v[36:39], a[140:143], a[184:187], v[36:39]
    ds_read_b128 a[220:223], v113 offset:22528
    v_mfma_f32_16x16x32_bf16 v[72:75], a[184:187], a[144:147], v[72:75]
    ds_read_b128 a[224:227], v112 offset:24576
    v_mfma_f32_16x16x32_bf16 v[72:75], a[188:191], a[156:159], v[72:75]
    buffer_load_dwordx4 v235, s[32:35], s52 offen offset:2048 lds
    v_mfma_f32_16x16x32_bf16 v[4:7], a[136:139], a[192:195], v[4:7]
    ds_read_b128 a[228:231], v113 offset:24576
    v_mfma_f32_16x16x32_bf16 v[4:7], a[148:151], a[196:199], v[4:7]
    ds_read_b128 a[232:235], v112 offset:33792
    v_mfma_f32_16x16x32_bf16 v[40:43], a[152:155], a[196:199], v[40:43]
    v_mfma_f32_16x16x32_bf16 v[40:43], a[140:143], a[192:195], v[40:43]
    buffer_load_dwordx4 v236, s[32:35], s52 offen offset:3072 lds
    v_mfma_f32_16x16x32_bf16 v[76:79], a[192:195], a[144:147], v[76:79]
    ds_read_b128 a[236:239], v113 offset:33792
    v_mfma_f32_16x16x32_bf16 v[76:79], a[196:199], a[156:159], v[76:79]
    ds_read_b128 a[240:243], v112 offset:35840
    s_waitcnt lgkmcnt(7)
    v_mfma_f32_16x16x32_bf16 v[8:11], a[136:139], a[200:203], v[8:11]
    s_add_u32 m0, s96, 53248
    v_mfma_f32_16x16x32_bf16 v[8:11], a[148:151], a[204:207], v[8:11]
    ds_read_b128 a[244:247], v113 offset:35840
    v_mfma_f32_16x16x32_bf16 v[44:47], a[152:155], a[204:207], v[44:47]
    ds_read_b128 a[248:251], v116 offset:4096
    v_mfma_f32_16x16x32_bf16 v[44:47], a[140:143], a[200:203], v[44:47]
    ds_read_b128 a[252:255], v117 offset:4096
    v_mfma_f32_16x16x32_bf16 v[80:83], a[200:203], a[144:147], v[80:83]
    s_movk_i32 s89, 0
    v_mfma_f32_16x16x32_bf16 v[80:83], a[204:207], a[156:159], v[80:83]
    buffer_load_dword v243, v252, s[76:79], s89 offen
    v_mfma_f32_16x16x32_bf16 v[12:15], a[136:139], a[208:211], v[12:15]
    buffer_load_dwordx4 v237, s[32:35], s52 offen offset:0 lds
    v_mfma_f32_16x16x32_bf16 v[12:15], a[148:151], a[212:215], v[12:15]
    buffer_load_dwordx4 v238, s[32:35], s52 offen offset:1024 lds
    v_mfma_f32_16x16x32_bf16 v[48:51], a[152:155], a[212:215], v[48:51]
    buffer_load_dwordx4 v239, s[32:35], s52 offen offset:2048 lds
    v_mfma_f32_16x16x32_bf16 v[48:51], a[140:143], a[208:211], v[48:51]
    v_mfma_f32_16x16x32_bf16 v[84:87], a[208:211], a[144:147], v[84:87]
    v_mfma_f32_16x16x32_bf16 v[84:87], a[212:215], a[156:159], v[84:87]
    s_addk_i32 s51, 128
    s_add_u32 s52, s52, s50
    s_waitcnt vmcnt(12) lgkmcnt(0)
    s_barrier
    v_mfma_f32_16x16x32_bf16 v[16:19], a[136:139], a[216:219], v[16:19]
    ds_read_b64_tr_b16 a[160:161], v118 offset:5120
    v_mfma_f32_16x16x32_bf16 v[16:19], a[148:151], a[220:223], v[16:19]
    ds_read_b64_tr_b16 a[162:163], v118 offset:5632
    s_add_u32 m0, s96, 90112
    v_mfma_f32_16x16x32_bf16 v[52:55], a[152:155], a[220:223], v[52:55]
    ds_read_b64_tr_b16 a[172:173], v118 offset:27648
    v_mfma_f32_16x16x32_bf16 v[52:55], a[140:143], a[216:219], v[52:55]
    buffer_load_dwordx4 v229, s[28:31], s51 offen offset:0 lds
    v_mfma_f32_16x16x32_bf16 v[88:91], a[216:219], a[144:147], v[88:91]
    v_mfma_f32_16x16x32_bf16 v[88:91], a[220:223], a[156:159], v[88:91]
    ds_read_b64_tr_b16 a[174:175], v118 offset:28160
    v_mfma_f32_16x16x32_bf16 v[20:23], a[136:139], a[224:227], v[20:23]
    ds_read_b64_tr_b16 a[164:165], v118 offset:7168
    v_mfma_f32_16x16x32_bf16 v[20:23], a[148:151], a[228:231], v[20:23]
    ds_read_b64_tr_b16 a[166:167], v118 offset:7680
    v_mfma_f32_16x16x32_bf16 v[56:59], a[152:155], a[228:231], v[56:59]
    buffer_load_dwordx4 v230, s[28:31], s51 offen offset:1024 lds
    v_mfma_f32_16x16x32_bf16 v[56:59], a[140:143], a[224:227], v[56:59]
    ds_read_b64_tr_b16 a[176:177], v118 offset:29696
    v_mfma_f32_16x16x32_bf16 v[92:95], a[224:227], a[144:147], v[92:95]
    ds_read_b64_tr_b16 a[178:179], v118 offset:30208
    v_mfma_f32_16x16x32_bf16 v[92:95], a[228:231], a[156:159], v[92:95]
    buffer_load_dwordx4 v231, s[28:31], s51 offen offset:2048 lds
    v_mfma_f32_16x16x32_bf16 v[24:27], a[136:139], a[232:235], v[24:27]
    ds_read_b64_tr_b16 a[168:169], v118 offset:9216
    v_mfma_f32_16x16x32_bf16 v[24:27], a[148:151], a[236:239], v[24:27]
    ds_read_b64_tr_b16 a[170:171], v118 offset:9728
    v_mfma_f32_16x16x32_bf16 v[60:63], a[152:155], a[236:239], v[60:63]
    ds_read_b64_tr_b16 a[180:181], v118 offset:31744
    v_mfma_f32_16x16x32_bf16 v[60:63], a[140:143], a[232:235], v[60:63]
    ds_read_b64_tr_b16 a[182:183], v118 offset:32256
    v_mfma_f32_16x16x32_bf16 v[96:99], a[232:235], a[144:147], v[96:99]
    buffer_load_dwordx4 v232, s[28:31], s51 offen offset:3072 lds
    v_mfma_f32_16x16x32_bf16 v[96:99], a[236:239], a[156:159], v[96:99]
    ds_read_b128 a[184:187], v108 offset:0
    v_mfma_f32_16x16x32_bf16 v[28:31], a[136:139], a[240:243], v[28:31]
    ds_read_b128 a[188:191], v109 offset:0
    v_mfma_f32_16x16x32_bf16 v[28:31], a[148:151], a[244:247], v[28:31]
    ds_read_b128 a[192:195], v108 offset:2048
    s_add_u32 m0, s96, 94208
    v_mfma_f32_16x16x32_bf16 v[64:67], a[152:155], a[244:247], v[64:67]
    ds_read_b128 a[196:199], v109 offset:2048
    v_mfma_f32_16x16x32_bf16 v[64:67], a[140:143], a[240:243], v[64:67]
    ds_read_b128 a[200:203], v108 offset:11264
    v_mfma_f32_16x16x32_bf16 v[100:103], a[240:243], a[144:147], v[100:103]
    s_mov_b32 exec_hi, s80
    buffer_load_dwordx4 v233, s[28:31], s51 offen offset:0 lds
    s_mov_b32 exec_hi, -1
    v_mfma_f32_16x16x32_bf16 v[100:103], a[244:247], a[156:159], v[100:103]
    v_mfma_f32_16x16x32_bf16 v[68:71], a[152:155], a[252:255], v[68:71]
    ds_read_b128 a[204:207], v109 offset:11264
    v_mfma_f32_16x16x32_bf16 v[68:71], a[140:143], a[248:251], v[68:71]
    ds_read_b128 a[208:211], v108 offset:13312
    v_mfma_f32_16x16x32_bf16 v[104:107], a[248:251], a[144:147], v[104:107]
    buffer_load_dwordx4 v234, s[32:35], s52 offen offset:1024 lds
    v_mfma_f32_16x16x32_bf16 v[104:107], a[252:255], a[156:159], v[104:107]
    ds_read_b128 a[212:215], v109 offset:13312
    s_waitcnt lgkmcnt(4)
    v_mfma_f32_16x16x32_bf16 v[0:3], a[160:163], a[184:187], v[0:3]
    ds_read_b128 a[216:219], v108 offset:22528
    v_mfma_f32_16x16x32_bf16 v[0:3], a[172:175], a[188:191], v[0:3]
    ds_read_b128 a[220:223], v109 offset:22528
    v_mfma_f32_16x16x32_bf16 v[36:39], a[176:179], a[188:191], v[36:39]
    v_mfma_f32_16x16x32_bf16 v[36:39], a[164:167], a[184:187], v[36:39]
    ds_read_b128 a[224:227], v108 offset:24576
    v_mfma_f32_16x16x32_bf16 v[72:75], a[184:187], a[168:171], v[72:75]
    ds_read_b128 a[228:231], v109 offset:24576
    v_mfma_f32_16x16x32_bf16 v[72:75], a[188:191], a[180:183], v[72:75]
    buffer_load_dwordx4 v235, s[32:35], s52 offen offset:2048 lds
    v_mfma_f32_16x16x32_bf16 v[4:7], a[160:163], a[192:195], v[4:7]
    v_mfma_f32_16x16x32_bf16 v[4:7], a[172:175], a[196:199], v[4:7]
    ds_read_b128 a[232:235], v108 offset:33792
    v_mfma_f32_16x16x32_bf16 v[40:43], a[176:179], a[196:199], v[40:43]
    ds_read_b128 a[236:239], v109 offset:33792
    v_mfma_f32_16x16x32_bf16 v[40:43], a[164:167], a[192:195], v[40:43]
    buffer_load_dwordx4 v236, s[32:35], s52 offen offset:3072 lds
    v_mfma_f32_16x16x32_bf16 v[76:79], a[192:195], a[168:171], v[76:79]
    v_mfma_f32_16x16x32_bf16 v[76:79], a[196:199], a[180:183], v[76:79]
    ds_read_b128 a[240:243], v108 offset:35840
    s_waitcnt lgkmcnt(7)
    v_mfma_f32_16x16x32_bf16 v[8:11], a[160:163], a[200:203], v[8:11]
    v_mfma_f32_16x16x32_bf16 v[8:11], a[172:175], a[204:207], v[8:11]
    ds_read_b128 a[244:247], v109 offset:35840
    v_mfma_f32_16x16x32_bf16 v[44:47], a[176:179], a[204:207], v[44:47]
    ds_read_b128 a[248:251], v114 offset:4096
    v_mfma_f32_16x16x32_bf16 v[44:47], a[164:167], a[200:203], v[44:47]
    s_add_u32 m0, s96, 98304
    v_mfma_f32_16x16x32_bf16 v[80:83], a[200:203], a[168:171], v[80:83]
    ds_read_b128 a[252:255], v115 offset:4096
    v_mfma_f32_16x16x32_bf16 v[80:83], a[204:207], a[180:183], v[80:83]
    buffer_load_dwordx4 v237, s[32:35], s52 offen offset:0 lds
    v_mfma_f32_16x16x32_bf16 v[12:15], a[160:163], a[208:211], v[12:15]
    v_mfma_f32_16x16x32_bf16 v[12:15], a[172:175], a[212:215], v[12:15]
    buffer_load_dwordx4 v238, s[32:35], s52 offen offset:1024 lds
    v_mfma_f32_16x16x32_bf16 v[48:51], a[176:179], a[212:215], v[48:51]
    buffer_load_dwordx4 v239, s[32:35], s52 offen offset:2048 lds
    v_mfma_f32_16x16x32_bf16 v[48:51], a[164:167], a[208:211], v[48:51]
    v_mfma_f32_16x16x32_bf16 v[84:87], a[208:211], a[168:171], v[84:87]
    v_mfma_f32_16x16x32_bf16 v[84:87], a[212:215], a[180:183], v[84:87]
    s_addk_i32 s51, 128
    s_add_u32 s52, s52, s50
    s_waitcnt vmcnt(11) lgkmcnt(0)
    s_barrier
    v_mfma_f32_16x16x32_bf16 v[16:19], a[160:163], a[216:219], v[16:19]
    ds_read_b64_tr_b16 a[136:137], v119 offset:5120
    v_mfma_f32_16x16x32_bf16 v[16:19], a[172:175], a[220:223], v[16:19]
    ds_read_b64_tr_b16 a[138:139], v119 offset:5632
    s_add_u32 m0, s96, 0
    v_mfma_f32_16x16x32_bf16 v[52:55], a[176:179], a[220:223], v[52:55]
    ds_read_b64_tr_b16 a[148:149], v119 offset:27648
    v_mfma_f32_16x16x32_bf16 v[52:55], a[164:167], a[216:219], v[52:55]
    buffer_load_dwordx4 v229, s[28:31], s51 offen offset:0 lds
    v_mfma_f32_16x16x32_bf16 v[88:91], a[216:219], a[168:171], v[88:91]
    ds_read_b64_tr_b16 a[150:151], v119 offset:28160
    v_mfma_f32_16x16x32_bf16 v[88:91], a[220:223], a[180:183], v[88:91]
    ds_read_b64_tr_b16 a[140:141], v119 offset:7168
    v_mfma_f32_16x16x32_bf16 v[20:23], a[160:163], a[224:227], v[20:23]
    buffer_load_dwordx4 v230, s[28:31], s51 offen offset:1024 lds
    v_mfma_f32_16x16x32_bf16 v[20:23], a[172:175], a[228:231], v[20:23]
    ds_read_b64_tr_b16 a[142:143], v119 offset:7680
    v_mfma_f32_16x16x32_bf16 v[56:59], a[176:179], a[228:231], v[56:59]
    ds_read_b64_tr_b16 a[152:153], v119 offset:29696
    v_mfma_f32_16x16x32_bf16 v[56:59], a[164:167], a[224:227], v[56:59]
    buffer_load_dword v208, v242, s[44:47], 0 offen sc1
    v_mfma_f32_16x16x32_bf16 v[92:95], a[224:227], a[168:171], v[92:95]
    ds_read_b64_tr_b16 a[154:155], v119 offset:30208
    v_mfma_f32_16x16x32_bf16 v[92:95], a[228:231], a[180:183], v[92:95]
    ds_read_b64_tr_b16 a[144:145], v119 offset:9216
    v_mfma_f32_16x16x32_bf16 v[24:27], a[160:163], a[232:235], v[24:27]
    buffer_load_dwordx4 v231, s[28:31], s51 offen offset:2048 lds
    v_mfma_f32_16x16x32_bf16 v[24:27], a[172:175], a[236:239], v[24:27]
    ds_read_b64_tr_b16 a[146:147], v119 offset:9728
    v_mfma_f32_16x16x32_bf16 v[60:63], a[176:179], a[236:239], v[60:63]
    ds_read_b64_tr_b16 a[156:157], v119 offset:31744
    v_mfma_f32_16x16x32_bf16 v[60:63], a[164:167], a[232:235], v[60:63]
    ds_read_b64_tr_b16 a[158:159], v119 offset:32256
    v_mfma_f32_16x16x32_bf16 v[96:99], a[232:235], a[168:171], v[96:99]
    ds_read_b128 a[184:187], v110 offset:0
    v_mfma_f32_16x16x32_bf16 v[96:99], a[236:239], a[180:183], v[96:99]
    buffer_load_dwordx4 v232, s[28:31], s51 offen offset:3072 lds
    v_mfma_f32_16x16x32_bf16 v[28:31], a[160:163], a[240:243], v[28:31]
    ds_read_b128 a[188:191], v111 offset:0
    v_mfma_f32_16x16x32_bf16 v[28:31], a[172:175], a[244:247], v[28:31]
    ds_read_b128 a[192:195], v110 offset:2048
    v_mfma_f32_16x16x32_bf16 v[64:67], a[176:179], a[244:247], v[64:67]
    ds_read_b128 a[196:199], v111 offset:2048
    s_add_u32 m0, s96, 4096
    v_mfma_f32_16x16x32_bf16 v[64:67], a[164:167], a[240:243], v[64:67]
    ds_read_b128 a[200:203], v110 offset:11264
    v_mfma_f32_16x16x32_bf16 v[100:103], a[240:243], a[168:171], v[100:103]
    s_mov_b32 exec_hi, s80
    buffer_load_dwordx4 v233, s[28:31], s51 offen offset:0 lds
    s_mov_b32 exec_hi, -1
    v_mfma_f32_16x16x32_bf16 v[100:103], a[244:247], a[180:183], v[100:103]
    v_mfma_f32_16x16x32_bf16 v[68:71], a[176:179], a[252:255], v[68:71]
    ds_read_b128 a[204:207], v111 offset:11264
    v_mfma_f32_16x16x32_bf16 v[68:71], a[164:167], a[248:251], v[68:71]
    ds_read_b128 a[208:211], v110 offset:13312
    v_mfma_f32_16x16x32_bf16 v[104:107], a[248:251], a[168:171], v[104:107]
    buffer_load_dwordx4 v234, s[32:35], s52 offen offset:1024 lds
    v_mfma_f32_16x16x32_bf16 v[104:107], a[252:255], a[180:183], v[104:107]
    ds_read_b128 a[212:215], v111 offset:13312
    s_waitcnt lgkmcnt(4)
    v_mfma_f32_16x16x32_bf16 v[0:3], a[136:139], a[184:187], v[0:3]
    ds_read_b128 a[216:219], v110 offset:22528
    v_mfma_f32_16x16x32_bf16 v[0:3], a[148:151], a[188:191], v[0:3]
    ds_read_b128 a[220:223], v111 offset:22528
    v_mfma_f32_16x16x32_bf16 v[36:39], a[152:155], a[188:191], v[36:39]
    v_mfma_f32_16x16x32_bf16 v[36:39], a[140:143], a[184:187], v[36:39]
    ds_read_b128 a[224:227], v110 offset:24576
    v_mfma_f32_16x16x32_bf16 v[72:75], a[184:187], a[144:147], v[72:75]
    buffer_load_dwordx4 v235, s[32:35], s52 offen offset:2048 lds
    v_mfma_f32_16x16x32_bf16 v[72:75], a[188:191], a[156:159], v[72:75]
    v_mfma_f32_16x16x32_bf16 v[4:7], a[136:139], a[192:195], v[4:7]
    ds_read_b128 a[228:231], v111 offset:24576
    v_mfma_f32_16x16x32_bf16 v[4:7], a[148:151], a[196:199], v[4:7]
    ds_read_b128 a[232:235], v110 offset:33792
    v_mfma_f32_16x16x32_bf16 v[40:43], a[152:155], a[196:199], v[40:43]
    buffer_load_dwordx4 v236, s[32:35], s52 offen offset:3072 lds
    v_mfma_f32_16x16x32_bf16 v[40:43], a[140:143], a[192:195], v[40:43]
    v_mfma_f32_16x16x32_bf16 v[76:79], a[192:195], a[144:147], v[76:79]
    ds_read_b128 a[236:239], v111 offset:33792
    v_mfma_f32_16x16x32_bf16 v[76:79], a[196:199], a[156:159], v[76:79]
    ds_read_b128 a[240:243], v110 offset:35840
    s_waitcnt lgkmcnt(7)
    v_mfma_f32_16x16x32_bf16 v[8:11], a[136:139], a[200:203], v[8:11]
    v_mfma_f32_16x16x32_bf16 v[8:11], a[148:151], a[204:207], v[8:11]
    ds_read_b128 a[244:247], v111 offset:35840
    s_add_u32 m0, s96, 8192
    v_mfma_f32_16x16x32_bf16 v[44:47], a[152:155], a[204:207], v[44:47]
    v_mfma_f32_16x16x32_bf16 v[44:47], a[140:143], a[200:203], v[44:47]
    ds_read_b128 a[248:251], v114 offset:49152
    v_mfma_f32_16x16x32_bf16 v[80:83], a[200:203], a[144:147], v[80:83]
    ds_read_b128 a[252:255], v115 offset:49152
    v_mfma_f32_16x16x32_bf16 v[80:83], a[204:207], a[156:159], v[80:83]
    buffer_load_dwordx4 v237, s[32:35], s52 offen offset:0 lds
    v_mfma_f32_16x16x32_bf16 v[12:15], a[136:139], a[208:211], v[12:15]
    v_mfma_f32_16x16x32_bf16 v[12:15], a[148:151], a[212:215], v[12:15]
    buffer_load_dwordx4 v238, s[32:35], s52 offen offset:1024 lds
    v_mfma_f32_16x16x32_bf16 v[48:51], a[152:155], a[212:215], v[48:51]
    buffer_load_dwordx4 v239, s[32:35], s52 offen offset:2048 lds
    v_mfma_f32_16x16x32_bf16 v[48:51], a[140:143], a[208:211], v[48:51]
    v_mfma_f32_16x16x32_bf16 v[84:87], a[208:211], a[144:147], v[84:87]
    v_mfma_f32_16x16x32_bf16 v[84:87], a[212:215], a[156:159], v[84:87]
    s_addk_i32 s51, 128
    s_add_u32 s52, s52, s50
    s_waitcnt vmcnt(12) lgkmcnt(0)
    s_barrier
    v_mfma_f32_16x16x32_bf16 v[16:19], a[136:139], a[216:219], v[16:19]
    ds_read_b64_tr_b16 a[160:161], v120 offset:5120
    s_waitcnt vmcnt(9)
    v_cmp_le_u32 vcc, 64, v208
    v_mfma_f32_16x16x32_bf16 v[16:19], a[148:151], a[220:223], v[16:19]
    ds_read_b64_tr_b16 a[162:163], v120 offset:5632
    v_mfma_f32_16x16x32_bf16 v[52:55], a[152:155], a[220:223], v[52:55]
    ds_read_b64_tr_b16 a[172:173], v120 offset:27648
    v_mfma_f32_16x16x32_bf16 v[52:55], a[140:143], a[216:219], v[52:55]
    s_cmp_eq_u64 vcc, -1
    s_cbranch_scc0 L_atsf_spin
L_atsf_ok:
    v_mfma_f32_16x16x32_bf16 v[88:91], a[216:219], a[144:147], v[88:91]
    ds_read_b64_tr_b16 a[174:175], v120 offset:28160
    s_lshl_b32 s87, s82, 8
    v_mfma_f32_16x16x32_bf16 v[88:91], a[220:223], a[156:159], v[88:91]
    s_add_u32 m0, s87, 159744
    s_mov_b32 s87, 9437184
    v_mfma_f32_16x16x32_bf16 v[20:23], a[136:139], a[224:227], v[20:23]
    buffer_load_dword v125, s[36:39], s87 offen sc1 lds
    v_mfma_f32_16x16x32_bf16 v[20:23], a[148:151], a[228:231], v[20:23]
    ds_read_b64_tr_b16 a[164:165], v120 offset:7168
    v_mfma_f32_16x16x32_bf16 v[56:59], a[152:155], a[228:231], v[56:59]
    ds_read_b64_tr_b16 a[166:167], v120 offset:7680
    s_mov_b32 s87, 9436164
    v_mfma_f32_16x16x32_bf16 v[56:59], a[140:143], a[224:227], v[56:59]
    buffer_load_dword v125, s[36:39], s87 offen offset:1024 sc1 lds
    v_mfma_f32_16x16x32_bf16 v[92:95], a[224:227], a[144:147], v[92:95]
    ds_read_b64_tr_b16 a[176:177], v120 offset:29696
    v_mfma_f32_16x16x32_bf16 v[92:95], a[228:231], a[156:159], v[92:95]
    ds_read_b64_tr_b16 a[178:179], v120 offset:30208
    s_mov_b32 s76, s8
    v_mfma_f32_16x16x32_bf16 v[24:27], a[136:139], a[232:235], v[24:27]
    s_mov_b32 s77, s9
    s_mov_b32 s78, 524288
    v_mfma_f32_16x16x32_bf16 v[24:27], a[148:151], a[236:239], v[24:27]
    ds_read_b64_tr_b16 a[168:169], v120 offset:9216
    s_add_u32 m0, s96, 45056
    v_mfma_f32_16x16x32_bf16 v[60:63], a[152:155], a[236:239], v[60:63]
    ds_read_b64_tr_b16 a[170:171], v120 offset:9728
    v_mfma_f32_16x16x32_bf16 v[60:63], a[140:143], a[232:235], v[60:63]
    ds_read_b64_tr_b16 a[180:181], v120 offset:31744
    buffer_load_dwordx4 v229, s[28:31], s51 offen offset:0 lds
    v_mfma_f32_16x16x32_bf16 v[96:99], a[232:235], a[144:147], v[96:99]
    ds_read_b64_tr_b16 a[182:183], v120 offset:32256
    v_mfma_f32_16x16x32_bf16 v[96:99], a[236:239], a[156:159], v[96:99]
    ds_read_b128 a[184:187], v112 offset:0
    v_mfma_f32_16x16x32_bf16 v[28:31], a[136:139], a[240:243], v[28:31]
    buffer_load_dwordx4 v230, s[28:31], s51 offen offset:1024 lds
    v_mfma_f32_16x16x32_bf16 v[28:31], a[148:151], a[244:247], v[28:31]
    ds_read_b128 a[188:191], v113 offset:0
    v_mfma_f32_16x16x32_bf16 v[64:67], a[152:155], a[244:247], v[64:67]
    buffer_load_dword v245, v245, s[76:79], 0 offen
    v_mfma_f32_16x16x32_bf16 v[64:67], a[140:143], a[240:243], v[64:67]
    ds_read_b128 a[192:195], v112 offset:2048
    v_mfma_f32_16x16x32_bf16 v[100:103], a[240:243], a[144:147], v[100:103]
    ds_read_b128 a[196:199], v113 offset:2048
    v_mfma_f32_16x16x32_bf16 v[100:103], a[244:247], a[156:159], v[100:103]
    buffer_load_dwordx4 v231, s[28:31], s51 offen offset:2048 lds
    v_mfma_f32_16x16x32_bf16 v[68:71], a[152:155], a[252:255], v[68:71]
    ds_read_b128 a[200:203], v112 offset:11264
    v_mfma_f32_16x16x32_bf16 v[68:71], a[140:143], a[248:251], v[68:71]
    ds_read_b128 a[204:207], v113 offset:11264
    ds_read_b128 a[208:211], v112 offset:13312
    v_mfma_f32_16x16x32_bf16 v[104:107], a[248:251], a[144:147], v[104:107]
    buffer_load_dwordx4 v232, s[28:31], s51 offen offset:3072 lds
    v_mfma_f32_16x16x32_bf16 v[104:107], a[252:255], a[156:159], v[104:107]
    ds_read_b128 a[212:215], v113 offset:13312
    s_waitcnt lgkmcnt(4)
    v_mfma_f32_16x16x32_bf16 v[0:3], a[160:163], a[184:187], v[0:3]
    ds_read_b128 a[216:219], v112 offset:22528
    s_add_u32 m0, s96, 49152
    v_mfma_f32_16x16x32_bf16 v[0:3], a[172:175], a[188:191], v[0:3]
    ds_read_b128 a[220:223], v113 offset:22528
    v_mfma_f32_16x16x32_bf16 v[36:39], a[176:179], a[188:191], v[36:39]
    ds_read_b128 a[224:227], v112 offset:24576
    s_add_u32 s88, s99, 0
    v_mfma_f32_16x16x32_bf16 v[36:39], a[164:167], a[184:187], v[36:39]
    buffer_load_dword v196, v126, s[36:39], s88 offen sc1
    v_mfma_f32_16x16x32_bf16 v[72:75], a[184:187], a[168:171], v[72:75]
    ds_read_b128 a[228:231], v113 offset:24576
    v_mfma_f32_16x16x32_bf16 v[72:75], a[188:191], a[180:183], v[72:75]
    s_mov_b32 exec_hi, s80
    buffer_load_dwordx4 v233, s[28:31], s51 offen offset:0 lds
    s_mov_b32 exec_hi, -1
    v_mfma_f32_16x16x32_bf16 v[4:7], a[160:163], a[192:195], v[4:7]
    ds_read_b128 a[232:235], v112 offset:33792
    v_mfma_f32_16x16x32_bf16 v[4:7], a[172:175], a[196:199], v[4:7]
    ds_read_b128 a[236:239], v113 offset:33792
    v_mfma_f32_16x16x32_bf16 v[40:43], a[176:179], a[196:199], v[40:43]
    buffer_load_dwordx4 v234, s[32:35], s52 offen offset:1024 lds
    v_mfma_f32_16x16x32_bf16 v[40:43], a[164:167], a[192:195], v[40:43]
    ds_read_b128 a[240:243], v112 offset:35840
    v_mfma_f32_16x16x32_bf16 v[76:79], a[192:195], a[168:171], v[76:79]
    ds_read_b128 a[244:247], v113 offset:35840
    v_mfma_f32_16x16x32_bf16 v[76:79], a[196:199], a[180:183], v[76:79]
    buffer_load_dwordx4 v235, s[32:35], s52 offen offset:2048 lds
    s_waitcnt lgkmcnt(8)
    v_mfma_f32_16x16x32_bf16 v[8:11], a[160:163], a[200:203], v[8:11]
    ds_read_b128 a[248:251], v116 offset:4096
    v_mfma_f32_16x16x32_bf16 v[8:11], a[172:175], a[204:207], v[8:11]
    buffer_load_dwordx4 v236, s[32:35], s52 offen offset:3072 lds
    v_mfma_f32_16x16x32_bf16 v[44:47], a[176:179], a[204:207], v[44:47]
    ds_read_b128 a[252:255], v117 offset:4096
    s_add_u32 s88, s99, 8192
    v_mfma_f32_16x16x32_bf16 v[44:47], a[164:167], a[200:203], v[44:47]
    buffer_load_dword v198, v126, s[36:39], s88 offen sc1
    v_mfma_f32_16x16x32_bf16 v[80:83], a[200:203], a[168:171], v[80:83]
    s_add_u32 m0, s96, 53248
    v_mfma_f32_16x16x32_bf16 v[80:83], a[204:207], a[180:183], v[80:83]
    buffer_load_dwordx4 v237, s[32:35], s52 offen offset:0 lds
    v_mfma_f32_16x16x32_bf16 v[12:15], a[160:163], a[208:211], v[12:15]
    s_add_u32 s88, s99, 16384
    v_mfma_f32_16x16x32_bf16 v[12:15], a[172:175], a[212:215], v[12:15]
    buffer_load_dword v200, v126, s[36:39], s88 offen sc1
    v_mfma_f32_16x16x32_bf16 v[48:51], a[176:179], a[212:215], v[48:51]
    buffer_load_dwordx4 v238, s[32:35], s52 offen offset:1024 lds
    v_mfma_f32_16x16x32_bf16 v[48:51], a[164:167], a[208:211], v[48:51]
    buffer_load_dwordx4 v239, s[32:35], s52 offen offset:2048 lds
    v_mfma_f32_16x16x32_bf16 v[84:87], a[208:211], a[168:171], v[84:87]
    v_mfma_f32_16x16x32_bf16 v[84:87], a[212:215], a[180:183], v[84:87]
    s_waitcnt vmcnt(17) lgkmcnt(0)
    s_barrier
    v_mfma_f32_16x16x32_bf16 v[16:19], a[160:163], a[216:219], v[16:19]
    ds_read_b64_tr_b16 a[136:137], v118 offset:5120
    s_add_u32 m0, s58, 0
    v_mfma_f32_16x16x32_bf16 v[16:19], a[172:175], a[220:223], v[16:19]
    s_add_u32 s53, s59, 0
    v_mfma_f32_16x16x32_bf16 v[52:55], a[176:179], a[220:223], v[52:55]
    buffer_load_dwordx4 v218, s[60:63], s53 offen offset:0 lds
    v_mfma_f32_16x16x32_bf16 v[52:55], a[164:167], a[216:219], v[52:55]
    ds_read_b64_tr_b16 a[138:139], v118 offset:5632
    v_mfma_f32_16x16x32_bf16 v[88:91], a[216:219], a[168:171], v[88:91]
    ds_read_b64_tr_b16 a[148:149], v118 offset:27648
    s_sub_u32 s76, s18, 2048
    s_subb_u32 s77, s19, 0
    v_mfma_f32_16x16x32_bf16 v[88:91], a[220:223], a[180:183], v[88:91]
    ds_read_b64_tr_b16 a[150:151], v118 offset:28160
    v_mfma_f32_16x16x32_bf16 v[20:23], a[160:163], a[224:227], v[20:23]
    ds_read_b64_tr_b16 a[140:141], v118 offset:7168
    v_mfma_f32_16x16x32_bf16 v[20:23], a[172:175], a[228:231], v[20:23]
    buffer_load_dwordx4 v219, s[60:63], s53 offen offset:1024 lds
    v_mfma_f32_16x16x32_bf16 v[56:59], a[176:179], a[228:231], v[56:59]
    ds_read_b64_tr_b16 a[142:143], v118 offset:7680
    v_mfma_f32_16x16x32_bf16 v[56:59], a[164:167], a[224:227], v[56:59]
    ds_read_b64_tr_b16 a[152:153], v118 offset:29696
    s_add_u32 m0, s96, 90112
    v_mfma_f32_16x16x32_bf16 v[92:95], a[224:227], a[168:171], v[92:95]
    s_add_u32 s53, s81, 0
    buffer_load_dwordx4 v218, s[60:63], s53 offen offset:0 lds
    v_mfma_f32_16x16x32_bf16 v[92:95], a[228:231], a[180:183], v[92:95]
    ds_read_b64_tr_b16 a[154:155], v118 offset:30208
    v_mfma_f32_16x16x32_bf16 v[24:27], a[160:163], a[232:235], v[24:27]
    ds_read_b64_tr_b16 a[144:145], v118 offset:9216
    s_movk_i32 s78, 3072
    v_mfma_f32_16x16x32_bf16 v[24:27], a[172:175], a[236:239], v[24:27]
    ds_read_b64_tr_b16 a[146:147], v118 offset:9728
    s_lshl_b32 s89, s82, 10
    v_mfma_f32_16x16x32_bf16 v[60:63], a[176:179], a[236:239], v[60:63]
    ds_read_b64_tr_b16 a[156:157], v118 offset:31744
    v_mfma_f32_16x16x32_bf16 v[60:63], a[164:167], a[232:235], v[60:63]
    buffer_load_dwordx4 v219, s[60:63], s53 offen offset:1024 lds
    v_mfma_f32_16x16x32_bf16 v[96:99], a[232:235], a[168:171], v[96:99]
    ds_read_b64_tr_b16 a[158:159], v118 offset:32256
    v_mfma_f32_16x16x32_bf16 v[96:99], a[236:239], a[180:183], v[96:99]
    ds_read_b128 a[184:187], v108 offset:0
    v_mfma_f32_16x16x32_bf16 v[28:31], a[160:163], a[240:243], v[28:31]
    s_add_u32 m0, s96, 92160
    s_add_u32 s53, s81, 16384
    v_mfma_f32_16x16x32_bf16 v[28:31], a[172:175], a[244:247], v[28:31]
    buffer_load_dwordx4 v218, s[60:63], s53 offen offset:0 lds
    v_mfma_f32_16x16x32_bf16 v[64:67], a[176:179], a[244:247], v[64:67]
    ds_read_b128 a[188:191], v109 offset:0
    v_mfma_f32_16x16x32_bf16 v[64:67], a[164:167], a[240:243], v[64:67]
    ds_read_b128 a[192:195], v108 offset:2048
    v_mfma_f32_16x16x32_bf16 v[100:103], a[240:243], a[168:171], v[100:103]
    ds_read_b128 a[196:199], v109 offset:2048
    v_mov_b32_e64 v233, v254
    v_mfma_f32_16x16x32_bf16 v[100:103], a[244:247], a[180:183], v[100:103]
    ds_read_b128 a[200:203], v108 offset:11264
    v_mfma_f32_16x16x32_bf16 v[68:71], a[176:179], a[252:255], v[68:71]
    ds_read_b128 a[204:207], v109 offset:11264
    v_mfma_f32_16x16x32_bf16 v[68:71], a[164:167], a[248:251], v[68:71]
    ds_read_b128 a[208:211], v108 offset:13312
    v_mfma_f32_16x16x32_bf16 v[104:107], a[248:251], a[168:171], v[104:107]
    buffer_load_dwordx4 v219, s[60:63], s53 offen offset:1024 lds
    v_mfma_f32_16x16x32_bf16 v[104:107], a[252:255], a[180:183], v[104:107]
    ds_read_b128 a[212:215], v109 offset:13312
    s_waitcnt lgkmcnt(4)
    v_mfma_f32_16x16x32_bf16 v[0:3], a[136:139], a[184:187], v[0:3]
    ds_read_b128 a[216:219], v108 offset:22528
    v_mfma_f32_16x16x32_bf16 v[0:3], a[148:151], a[188:191], v[0:3]
    v_add_u32 v229, s89, v233
    v_mfma_f32_16x16x32_bf16 v[36:39], a[152:155], a[188:191], v[36:39]
    ds_read_b128 a[220:223], v109 offset:22528
    v_mfma_f32_16x16x32_bf16 v[36:39], a[140:143], a[184:187], v[36:39]
    ds_read_b128 a[224:227], v108 offset:24576
    v_mfma_f32_16x16x32_bf16 v[72:75], a[184:187], a[144:147], v[72:75]
    s_add_u32 m0, s96, 94208
    s_add_u32 s53, s94, 0
    v_mfma_f32_16x16x32_bf16 v[72:75], a[188:191], a[156:159], v[72:75]
    buffer_load_dwordx4 v218, s[60:63], s53 offen offset:0 lds
    v_mfma_f32_16x16x32_bf16 v[4:7], a[136:139], a[192:195], v[4:7]
    ds_read_b128 a[228:231], v109 offset:24576
    v_mfma_f32_16x16x32_bf16 v[4:7], a[148:151], a[196:199], v[4:7]
    ds_read_b128 a[232:235], v108 offset:33792
    v_mfma_f32_16x16x32_bf16 v[40:43], a[152:155], a[196:199], v[40:43]
    buffer_load_dwordx4 v219, s[60:63], s53 offen offset:1024 lds
    v_mfma_f32_16x16x32_bf16 v[40:43], a[140:143], a[192:195], v[40:43]
    ds_read_b128 a[236:239], v109 offset:33792
    v_mfma_f32_16x16x32_bf16 v[76:79], a[192:195], a[144:147], v[76:79]
    ds_read_b128 a[240:243], v108 offset:35840
    v_xor_b32 v230, 1024, v229
    v_mfma_f32_16x16x32_bf16 v[76:79], a[196:199], a[156:159], v[76:79]
    ds_read_b128 a[244:247], v109 offset:35840
    s_waitcnt lgkmcnt(8)
    v_mfma_f32_16x16x32_bf16 v[8:11], a[136:139], a[200:203], v[8:11]
    ds_read_b128 a[248:251], v114 offset:4096
    v_mfma_f32_16x16x32_bf16 v[8:11], a[148:151], a[204:207], v[8:11]
    s_add_u32 m0, s96, 96256
    s_add_u32 s53, s94, 16384
    v_mfma_f32_16x16x32_bf16 v[44:47], a[152:155], a[204:207], v[44:47]
    buffer_load_dwordx4 v218, s[60:63], s53 offen offset:0 lds
    v_mfma_f32_16x16x32_bf16 v[44:47], a[140:143], a[200:203], v[44:47]
    ds_read_b128 a[252:255], v115 offset:4096
    v_mfma_f32_16x16x32_bf16 v[80:83], a[200:203], a[144:147], v[80:83]
    buffer_load_dwordx4 v219, s[60:63], s53 offen offset:1024 lds
    v_mfma_f32_16x16x32_bf16 v[80:83], a[204:207], a[156:159], v[80:83]
    s_add_u32 m0, s96, 98304
    s_add_u32 s53, s95, 0
    v_xor_b32 v231, 2048, v229
    v_mfma_f32_16x16x32_bf16 v[12:15], a[136:139], a[208:211], v[12:15]
    buffer_load_dwordx4 v218, s[60:63], s53 offen offset:0 lds
    v_mfma_f32_16x16x32_bf16 v[12:15], a[148:151], a[212:215], v[12:15]
    v_xor_b32 v232, 3072, v229
    v_mfma_f32_16x16x32_bf16 v[48:51], a[152:155], a[212:215], v[48:51]
    buffer_load_dwordx4 v219, s[60:63], s53 offen offset:1024 lds
    v_mfma_f32_16x16x32_bf16 v[48:51], a[140:143], a[208:211], v[48:51]
    v_mfma_f32_16x16x32_bf16 v[84:87], a[208:211], a[144:147], v[84:87]
    v_mfma_f32_16x16x32_bf16 v[84:87], a[212:215], a[156:159], v[84:87]
    s_waitcnt vmcnt(12) lgkmcnt(0)
    s_barrier
    v_mfma_f32_16x16x32_bf16 v[16:19], a[136:139], a[216:219], v[16:19]
    ds_read_b64_tr_b16 a[160:161], v119 offset:5120
    s_add_u32 m0, s58, 2048
    v_mfma_f32_16x16x32_bf16 v[16:19], a[148:151], a[220:223], v[16:19]
    s_add_u32 s53, s59, 16384
    v_mfma_f32_16x16x32_bf16 v[52:55], a[152:155], a[220:223], v[52:55]
    buffer_load_dwordx4 v218, s[60:63], s53 offen offset:0 lds
    v_mfma_f32_16x16x32_bf16 v[52:55], a[140:143], a[216:219], v[52:55]
    ds_read_b64_tr_b16 a[162:163], v119 offset:5632
    v_mfma_f32_16x16x32_bf16 v[88:91], a[216:219], a[144:147], v[88:91]
    ds_read_b64_tr_b16 a[172:173], v119 offset:27648
    v_mfma_f32_16x16x32_bf16 v[88:91], a[220:223], a[156:159], v[88:91]
    ds_read_b64_tr_b16 a[174:175], v119 offset:28160
    v_mfma_f32_16x16x32_bf16 v[20:23], a[136:139], a[224:227], v[20:23]
    buffer_load_dwordx4 v219, s[60:63], s53 offen offset:1024 lds
    v_mfma_f32_16x16x32_bf16 v[20:23], a[148:151], a[228:231], v[20:23]
    ds_read_b64_tr_b16 a[164:165], v119 offset:7168
    v_mfma_f32_16x16x32_bf16 v[56:59], a[152:155], a[228:231], v[56:59]
    ds_read_b64_tr_b16 a[166:167], v119 offset:7680
    s_add_u32 m0, s96, 0
    v_mfma_f32_16x16x32_bf16 v[56:59], a[140:143], a[224:227], v[56:59]
    s_add_u32 s53, s95, 16384
    v_mfma_f32_16x16x32_bf16 v[92:95], a[224:227], a[144:147], v[92:95]
    buffer_load_dwordx4 v218, s[60:63], s53 offen offset:0 lds
    v_mfma_f32_16x16x32_bf16 v[92:95], a[228:231], a[156:159], v[92:95]
    ds_read_b64_tr_b16 a[176:177], v119 offset:29696
    v_mfma_f32_16x16x32_bf16 v[24:27], a[136:139], a[232:235], v[24:27]
    ds_read_b64_tr_b16 a[178:179], v119 offset:30208
    v_mfma_f32_16x16x32_bf16 v[24:27], a[148:151], a[236:239], v[24:27]
    ds_read_b64_tr_b16 a[168:169], v119 offset:9216
    v_mfma_f32_16x16x32_bf16 v[60:63], a[152:155], a[236:239], v[60:63]
    ds_read_b64_tr_b16 a[170:171], v119 offset:9728
    ds_read_b64_tr_b16 a[180:181], v119 offset:31744
    v_mfma_f32_16x16x32_bf16 v[60:63], a[140:143], a[232:235], v[60:63]
    buffer_load_dwordx4 v219, s[60:63], s53 offen offset:1024 lds
    v_mfma_f32_16x16x32_bf16 v[96:99], a[232:235], a[144:147], v[96:99]
    ds_read_b64_tr_b16 a[182:183], v119 offset:32256
    v_mfma_f32_16x16x32_bf16 v[96:99], a[236:239], a[156:159], v[96:99]
    ds_read_b128 a[184:187], v110 offset:0
    v_mfma_f32_16x16x32_bf16 v[28:31], a[136:139], a[240:243], v[28:31]
    ds_read_b128 a[188:191], v111 offset:0
    v_mfma_f32_16x16x32_bf16 v[28:31], a[148:151], a[244:247], v[28:31]
    s_add_u32 m0, s96, 2048
    s_xor_b32 s53, s93, 196608
    v_mfma_f32_16x16x32_bf16 v[64:67], a[152:155], a[244:247], v[64:67]
    buffer_load_dwordx4 v220, s[60:63], s53 offen offset:0 lds
    v_mfma_f32_16x16x32_bf16 v[64:67], a[140:143], a[240:243], v[64:67]
    ds_read_b128 a[192:195], v110 offset:2048
    v_mfma_f32_16x16x32_bf16 v[100:103], a[240:243], a[144:147], v[100:103]
    ds_read_b128 a[196:199], v111 offset:2048
    v_mfma_f32_16x16x32_bf16 v[100:103], a[244:247], a[156:159], v[100:103]
    buffer_load_dwordx4 v221, s[60:63], s53 offen offset:1024 lds
    v_mfma_f32_16x16x32_bf16 v[68:71], a[152:155], a[252:255], v[68:71]
    ds_read_b128 a[200:203], v110 offset:11264
    v_mfma_f32_16x16x32_bf16 v[68:71], a[140:143], a[248:251], v[68:71]
    ds_read_b128 a[204:207], v111 offset:11264
    v_mfma_f32_16x16x32_bf16 v[104:107], a[248:251], a[144:147], v[104:107]
    ds_read_b128 a[208:211], v110 offset:13312
    v_mfma_f32_16x16x32_bf16 v[104:107], a[252:255], a[156:159], v[104:107]
    ds_read_b128 a[212:215], v111 offset:13312
    s_waitcnt lgkmcnt(4)
    v_mfma_f32_16x16x32_bf16 v[0:3], a[160:163], a[184:187], v[0:3]
    ds_read_b128 a[216:219], v110 offset:22528
    v_mfma_f32_16x16x32_bf16 v[0:3], a[172:175], a[188:191], v[0:3]
    ds_read_b128 a[220:223], v111 offset:22528
    v_mfma_f32_16x16x32_bf16 v[36:39], a[176:179], a[188:191], v[36:39]
    ds_read_b128 a[224:227], v110 offset:24576
    v_mfma_f32_16x16x32_bf16 v[36:39], a[164:167], a[184:187], v[36:39]
    ds_read_b128 a[228:231], v111 offset:24576
    s_add_u32 m0, s96, 4096
    v_mfma_f32_16x16x32_bf16 v[72:75], a[184:187], a[168:171], v[72:75]
    s_xor_b32 s53, s93, 200704
    v_mfma_f32_16x16x32_bf16 v[72:75], a[188:191], a[180:183], v[72:75]
    buffer_load_dwordx4 v220, s[60:63], s53 offen offset:0 lds
    v_mfma_f32_16x16x32_bf16 v[4:7], a[160:163], a[192:195], v[4:7]
    ds_read_b128 a[232:235], v110 offset:33792
    v_mfma_f32_16x16x32_bf16 v[4:7], a[172:175], a[196:199], v[4:7]
    ds_read_b128 a[236:239], v111 offset:33792
    v_mfma_f32_16x16x32_bf16 v[40:43], a[176:179], a[196:199], v[40:43]
    buffer_load_dwordx4 v221, s[60:63], s53 offen offset:1024 lds
    v_mfma_f32_16x16x32_bf16 v[40:43], a[164:167], a[192:195], v[40:43]
    ds_read_b128 a[240:243], v110 offset:35840
    v_mfma_f32_16x16x32_bf16 v[76:79], a[192:195], a[168:171], v[76:79]
    ds_read_b128 a[244:247], v111 offset:35840
    v_mfma_f32_16x16x32_bf16 v[76:79], a[196:199], a[180:183], v[76:79]
    ds_read_b128 a[248:251], v114 offset:49152
    s_waitcnt lgkmcnt(9)
    v_mfma_f32_16x16x32_bf16 v[8:11], a[160:163], a[200:203], v[8:11]
    s_waitcnt vmcnt(18)
    ds_read_b64_tr_b16 a[0:1], v226 offset:0
    v_mfma_f32_16x16x32_bf16 v[8:11], a[172:175], a[204:207], v[8:11]
    ds_read_b64_tr_b16 a[4:5], v227 offset:0
    v_mfma_f32_16x16x32_bf16 v[44:47], a[176:179], a[204:207], v[44:47]
    ds_read_b128 a[252:255], v115 offset:49152
    s_add_u32 m0, s96, 6144
    v_mfma_f32_16x16x32_bf16 v[44:47], a[164:167], a[200:203], v[44:47]
    s_xor_b32 s53, s93, 229376
    v_mfma_f32_16x16x32_bf16 v[80:83], a[200:203], a[168:171], v[80:83]
    buffer_load_dwordx4 v220, s[60:63], s53 offen offset:0 lds
    v_mfma_f32_16x16x32_bf16 v[80:83], a[204:207], a[180:183], v[80:83]
    buffer_load_dwordx4 v221, s[60:63], s53 offen offset:1024 lds
    v_mfma_f32_16x16x32_bf16 v[12:15], a[160:163], a[208:211], v[12:15]
    s_add_u32 m0, s96, 8192
    s_xor_b32 s53, s93, 233472
    v_mfma_f32_16x16x32_bf16 v[12:15], a[172:175], a[212:215], v[12:15]
    buffer_load_dwordx4 v220, s[60:63], s53 offen offset:0 lds
    v_mfma_f32_16x16x32_bf16 v[48:51], a[176:179], a[212:215], v[48:51]
    ds_read_b64_tr_b16 a[8:9], v226 offset:512
    v_mfma_f32_16x16x32_bf16 v[48:51], a[164:167], a[208:211], v[48:51]
    ds_read_b64_tr_b16 a[12:13], v227 offset:512
    v_mfma_f32_16x16x32_bf16 v[84:87], a[208:211], a[168:171], v[84:87]
    buffer_load_dwordx4 v221, s[60:63], s53 offen offset:1024 lds
    v_mfma_f32_16x16x32_bf16 v[84:87], a[212:215], a[180:183], v[84:87]
    s_waitcnt lgkmcnt(2)
    s_barrier
    v_mfma_f32_16x16x16_bf16 v[152:155], v[196:197], v[148:149], 0
    ds_read_b32 v160, v121 offset:0
    v_mfma_f32_16x16x16_bf16 v[156:159], v[198:199], v[148:149], 0
    ds_read_b32 v161, v121 offset:1024
    s_waitcnt vmcnt(20)
    ds_read_b64_tr_b16 a[16:17], v224 offset:0
    v_mfma_f32_16x16x16_bf16 v[32:35], v[148:149], v[200:201], 0
    ds_read_b64_tr_b16 a[20:21], v225 offset:0
    ds_read_b64_tr_b16 a[24:25], v224 offset:512
    v_mfma_f32_16x16x32_bf16 v[16:19], a[160:163], a[216:219], v[16:19]
    ds_read_b64_tr_b16 a[28:29], v225 offset:512
    s_add_u32 m0, s96, 45056
    v_mfma_f32_16x16x32_bf16 v[16:19], a[172:175], a[220:223], v[16:19]
    s_add_u32 s53, s59, 65536
    buffer_load_dwordx4 v218, s[60:63], s53 offen offset:0 lds
    v_mfma_f32_16x16x32_bf16 v[52:55], a[176:179], a[220:223], v[52:55]
    buffer_load_dwordx4 v219, s[60:63], s53 offen offset:1024 lds
    v_mfma_f32_16x16x32_bf16 v[52:55], a[164:167], a[216:219], v[52:55]
    ds_read_b32 v162, v121 offset:64
    v_mfma_f32_16x16x32_bf16 v[88:91], a[216:219], a[168:171], v[88:91]
    ds_read_b32 v163, v121 offset:1088
    ds_read_b32 v164, v121 offset:128
    v_mfma_f32_16x16x32_bf16 v[88:91], a[220:223], a[180:183], v[88:91]
    ds_read_b32 v165, v121 offset:1152
    v_mfma_f32_16x16x32_bf16 v[20:23], a[160:163], a[224:227], v[20:23]
    s_waitcnt vmcnt(20)
    ds_read_b64_tr_b16 a[18:19], v224 offset:2048
    ds_read_b64_tr_b16 a[22:23], v225 offset:2048
    v_mfma_f32_16x16x32_bf16 v[20:23], a[172:175], a[228:231], v[20:23]
    ds_read_b64_tr_b16 a[26:27], v224 offset:2560
    v_mfma_f32_16x16x32_bf16 v[56:59], a[176:179], a[228:231], v[56:59]
    ds_read_b64_tr_b16 a[30:31], v225 offset:2560
    s_add_u32 m0, s96, 47104
    s_add_u32 s53, s59, 81920
    v_mfma_f32_16x16x32_bf16 v[56:59], a[164:167], a[224:227], v[56:59]
    buffer_load_dwordx4 v218, s[60:63], s53 offen offset:0 lds
    v_mfma_f32_16x16x32_bf16 v[92:95], a[224:227], a[168:171], v[92:95]
    buffer_load_dwordx4 v219, s[60:63], s53 offen offset:1024 lds
    v_mfma_f32_16x16x32_bf16 v[92:95], a[228:231], a[180:183], v[92:95]
    ds_read_b32 v166, v121 offset:192
    ds_read_b32 v167, v121 offset:1216
    v_mfma_f32_16x16x32_bf16 v[24:27], a[160:163], a[232:235], v[24:27]
    ds_read_b32 v168, v121 offset:256
    ds_read_b32 v169, v121 offset:1280
    v_mfma_f32_16x16x32_bf16 v[24:27], a[172:175], a[236:239], v[24:27]
    s_waitcnt vmcnt(20)
    ds_read_b64_tr_b16 a[32:33], v224 offset:4096
    v_mfma_f32_16x16x32_bf16 v[60:63], a[176:179], a[236:239], v[60:63]
    ds_read_b64_tr_b16 a[36:37], v225 offset:4096
    ds_read_b64_tr_b16 a[40:41], v224 offset:4608
    v_mfma_f32_16x16x32_bf16 v[60:63], a[164:167], a[232:235], v[60:63]
    ds_read_b64_tr_b16 a[44:45], v225 offset:4608
    v_mfma_f32_16x16x32_bf16 v[96:99], a[232:235], a[168:171], v[96:99]
    ds_read_b32 v170, v121 offset:320
    ds_read_b32 v171, v121 offset:1344
    v_mfma_f32_16x16x32_bf16 v[96:99], a[236:239], a[180:183], v[96:99]
    s_add_u32 m0, s96, 49152
    s_add_u32 s53, s81, 65536
    buffer_load_dwordx4 v218, s[60:63], s53 offen offset:0 lds
    v_mfma_f32_16x16x32_bf16 v[28:31], a[160:163], a[240:243], v[28:31]
    buffer_load_dwordx4 v219, s[60:63], s53 offen offset:1024 lds
    v_mfma_f32_16x16x32_bf16 v[28:31], a[172:175], a[244:247], v[28:31]
    s_waitcnt vmcnt(16)
    ds_read_b64_tr_b16 a[2:3], v226 offset:2048
    v_mfma_f32_16x16x32_bf16 v[64:67], a[176:179], a[244:247], v[64:67]
    ds_read_b64_tr_b16 a[6:7], v227 offset:2048
    v_mfma_f32_16x16x32_bf16 v[64:67], a[164:167], a[240:243], v[64:67]
    ds_read_b32 v172, v121 offset:384
    ds_read_b32 v173, v121 offset:1408
    v_mfma_f32_16x16x32_bf16 v[100:103], a[240:243], a[168:171], v[100:103]
    ds_read_b32 v174, v121 offset:448
    ds_read_b32 v175, v121 offset:1472
    v_mfma_f32_16x16x32_bf16 v[100:103], a[244:247], a[180:183], v[100:103]
    s_add_u32 m0, s96, 51200
    s_add_u32 s53, s81, 81920
    v_mfma_f32_16x16x32_bf16 v[68:71], a[176:179], a[252:255], v[68:71]
    buffer_load_dwordx4 v218, s[60:63], s53 offen offset:0 lds
    v_mfma_f32_16x16x32_bf16 v[68:71], a[164:167], a[248:251], v[68:71]
    buffer_load_dwordx4 v219, s[60:63], s53 offen offset:1024 lds
    v_mfma_f32_16x16x32_bf16 v[104:107], a[248:251], a[168:171], v[104:107]
    ds_read_b64_tr_b16 a[10:11], v226 offset:2560
    ds_read_b64_tr_b16 a[14:15], v227 offset:2560
    v_mfma_f32_16x16x32_bf16 v[104:107], a[252:255], a[180:183], v[104:107]
    ds_read_b32 v176, v121 offset:512
    ds_read_b32 v177, v121 offset:1536
    v_mov_b32 v178, v122
    v_mov_b32_e64 v179, v123
    ds_read_b128 v[186:189], v178 offset:0
    ds_read_b128 v[190:193], v178 offset:1024
    ds_read_b128 v[194:197], v178 offset:64
    ds_read_b128 v[198:201], v178 offset:1088
    ds_read_b128 v[202:205], v178 offset:128
    ds_read_b128 v[206:209], v178 offset:1152
    ds_read_b128 v[210:213], v178 offset:192
    ds_read_b128 v[214:217], v178 offset:1216
    s_waitcnt lgkmcnt(8)
    v_pk_fma_f32 v[36:37], v[156:157], v[160:161], v[36:37] op_sel_hi:[1,0,1]
    v_pk_fma_f32 v[38:39], v[158:159], v[160:161], v[38:39] op_sel_hi:[1,0,1]
    v_pk_fma_f32 v[0:1], v[152:153], v[160:161], v[0:1] op_sel_hi:[1,0,1]
    v_pk_fma_f32 v[2:3], v[154:155], v[160:161], v[2:3] op_sel_hi:[1,0,1]
    v_pk_mul_f32 v[36:37], v[36:37], v[160:161] op_sel:[0,1] op_sel_hi:[1,1]
    v_pk_mul_f32 v[38:39], v[38:39], v[160:161] op_sel:[0,1] op_sel_hi:[1,1]
    v_cvt_pk_bf16_f32 v0, v0, v1
    v_cvt_pk_bf16_f32 v1, v2, v3
    v_mul_f32 v161, 0x3eb8aa3b, v161
    v_cvt_pk_bf16_f32 v36, v36, v37
    v_cvt_pk_bf16_f32 v37, v38, v39
    v_pk_fma_f32 v[40:41], v[156:157], v[162:163], v[40:41] op_sel_hi:[1,0,1]
    v_pk_fma_f32 v[42:43], v[158:159], v[162:163], v[42:43] op_sel_hi:[1,0,1]
    v_pk_fma_f32 v[4:5], v[152:153], v[162:163], v[4:5] op_sel_hi:[1,0,1]
    v_pk_fma_f32 v[6:7], v[154:155], v[162:163], v[6:7] op_sel_hi:[1,0,1]
    v_pk_mul_f32 v[40:41], v[40:41], v[162:163] op_sel:[0,1] op_sel_hi:[1,1]
    s_add_u32 m0, s96, 53248
    s_add_u32 s53, s94, 65536
    buffer_load_dwordx4 v218, s[60:63], s53 offen offset:0 lds
    buffer_load_dwordx4 v219, s[60:63], s53 offen offset:1024 lds
    s_add_u32 m0, s96, 90112
    s_add_u32 s53, s94, 81920
    buffer_load_dwordx4 v218, s[60:63], s53 offen offset:0 lds
    buffer_load_dwordx4 v219, s[60:63], s53 offen offset:1024 lds
    ds_read_b64_tr_b16 a[34:35], v224 offset:6144
    ds_read_b64_tr_b16 a[38:39], v225 offset:6144
    ds_read_b64_tr_b16 a[42:43], v224 offset:6656
    ds_read_b64_tr_b16 a[46:47], v225 offset:6656
    ds_read_b64_tr_b16 a[48:49], v224 offset:8192
    ds_read_b64_tr_b16 a[52:53], v225 offset:8192
    ds_read_b64_tr_b16 a[56:57], v224 offset:8704
    ds_read_b64_tr_b16 a[60:61], v225 offset:8704
    v_pk_mul_f32 v[42:43], v[42:43], v[162:163] op_sel:[0,1] op_sel_hi:[1,1]
    v_cvt_pk_bf16_f32 v4, v4, v5
    v_cvt_pk_bf16_f32 v5, v6, v7
    v_mul_f32 v163, 0x3eb8aa3b, v163
    v_cvt_pk_bf16_f32 v40, v40, v41
    v_cvt_pk_bf16_f32 v41, v42, v43
    v_pk_fma_f32 v[44:45], v[156:157], v[164:165], v[44:45] op_sel_hi:[1,0,1]
    v_pk_fma_f32 v[46:47], v[158:159], v[164:165], v[46:47] op_sel_hi:[1,0,1]
    v_pk_fma_f32 v[8:9], v[152:153], v[164:165], v[8:9] op_sel_hi:[1,0,1]
    v_pk_fma_f32 v[10:11], v[154:155], v[164:165], v[10:11] op_sel_hi:[1,0,1]
    v_pk_mul_f32 v[44:45], v[44:45], v[164:165] op_sel:[0,1] op_sel_hi:[1,1]
    v_pk_mul_f32 v[46:47], v[46:47], v[164:165] op_sel:[0,1] op_sel_hi:[1,1]
    v_cvt_pk_bf16_f32 v8, v8, v9
    v_cvt_pk_bf16_f32 v9, v10, v11
    v_mul_f32 v165, 0x3eb8aa3b, v165
    v_cvt_pk_bf16_f32 v44, v44, v45
    v_cvt_pk_bf16_f32 v45, v46, v47
    v_pk_fma_f32 v[48:49], v[156:157], v[166:167], v[48:49] op_sel_hi:[1,0,1]
    v_pk_fma_f32 v[50:51], v[158:159], v[166:167], v[50:51] op_sel_hi:[1,0,1]
    v_pk_fma_f32 v[12:13], v[152:153], v[166:167], v[12:13] op_sel_hi:[1,0,1]
    v_pk_fma_f32 v[14:15], v[154:155], v[166:167], v[14:15] op_sel_hi:[1,0,1]
    v_pk_mul_f32 v[48:49], v[48:49], v[166:167] op_sel:[0,1] op_sel_hi:[1,1]
    v_pk_mul_f32 v[50:51], v[50:51], v[166:167] op_sel:[0,1] op_sel_hi:[1,1]
    v_cvt_pk_bf16_f32 v12, v12, v13
    v_cvt_pk_bf16_f32 v13, v14, v15
    v_mul_f32 v167, 0x3eb8aa3b, v167
    v_cvt_pk_bf16_f32 v48, v48, v49
    v_cvt_pk_bf16_f32 v49, v50, v51
    v_pk_fma_f32 v[52:53], v[156:157], v[168:169], v[52:53] op_sel_hi:[1,0,1]
    v_pk_fma_f32 v[54:55], v[158:159], v[168:169], v[54:55] op_sel_hi:[1,0,1]
    v_pk_fma_f32 v[16:17], v[152:153], v[168:169], v[16:17] op_sel_hi:[1,0,1]
    v_pk_fma_f32 v[18:19], v[154:155], v[168:169], v[18:19] op_sel_hi:[1,0,1]
    v_pk_mul_f32 v[52:53], v[52:53], v[168:169] op_sel:[0,1] op_sel_hi:[1,1]
    v_pk_mul_f32 v[54:55], v[54:55], v[168:169] op_sel:[0,1] op_sel_hi:[1,1]
    v_cvt_pk_bf16_f32 v16, v16, v17
    s_add_u32 m0, s96, 92160
    s_add_u32 s53, s95, 65536
    buffer_load_dwordx4 v218, s[60:63], s53 offen offset:0 lds
    buffer_load_dwordx4 v219, s[60:63], s53 offen offset:1024 lds
    s_add_u32 m0, s96, 94208
    s_add_u32 s53, s95, 81920
    buffer_load_dwordx4 v218, s[60:63], s53 offen offset:0 lds
    buffer_load_dwordx4 v219, s[60:63], s53 offen offset:1024 lds
    s_waitcnt vmcnt(22)
    ds_read_b64_tr_b16 a[50:51], v222 offset:0
    ds_read_b64_tr_b16 a[54:55], v223 offset:0
    ds_read_b64_tr_b16 a[58:59], v222 offset:512
    ds_read_b64_tr_b16 a[62:63], v223 offset:512
    ds_read_b64_tr_b16 a[64:65], v222 offset:2048
    ds_read_b64_tr_b16 a[68:69], v223 offset:2048
    ds_read_b64_tr_b16 a[72:73], v222 offset:2560
    ds_read_b64_tr_b16 a[76:77], v223 offset:2560
    v_cvt_pk_bf16_f32 v17, v18, v19
    v_mul_f32 v169, 0x3eb8aa3b, v169
    v_cvt_pk_bf16_f32 v52, v52, v53
    v_cvt_pk_bf16_f32 v53, v54, v55
    v_pk_fma_f32 v[56:57], v[156:157], v[170:171], v[56:57] op_sel_hi:[1,0,1]
    v_pk_fma_f32 v[58:59], v[158:159], v[170:171], v[58:59] op_sel_hi:[1,0,1]
    v_pk_fma_f32 v[20:21], v[152:153], v[170:171], v[20:21] op_sel_hi:[1,0,1]
    v_pk_fma_f32 v[22:23], v[154:155], v[170:171], v[22:23] op_sel_hi:[1,0,1]
    v_pk_mul_f32 v[56:57], v[56:57], v[170:171] op_sel:[0,1] op_sel_hi:[1,1]
    v_pk_mul_f32 v[58:59], v[58:59], v[170:171] op_sel:[0,1] op_sel_hi:[1,1]
    v_cvt_pk_bf16_f32 v20, v20, v21
    v_cvt_pk_bf16_f32 v21, v22, v23
    v_mul_f32 v171, 0x3eb8aa3b, v171
    v_cvt_pk_bf16_f32 v56, v56, v57
    v_cvt_pk_bf16_f32 v57, v58, v59
    v_pk_fma_f32 v[60:61], v[156:157], v[172:173], v[60:61] op_sel_hi:[1,0,1]
    v_pk_fma_f32 v[62:63], v[158:159], v[172:173], v[62:63] op_sel_hi:[1,0,1]
    v_pk_fma_f32 v[24:25], v[152:153], v[172:173], v[24:25] op_sel_hi:[1,0,1]
    v_pk_fma_f32 v[26:27], v[154:155], v[172:173], v[26:27] op_sel_hi:[1,0,1]
    v_pk_mul_f32 v[60:61], v[60:61], v[172:173] op_sel:[0,1] op_sel_hi:[1,1]
    v_pk_mul_f32 v[62:63], v[62:63], v[172:173] op_sel:[0,1] op_sel_hi:[1,1]
    v_cvt_pk_bf16_f32 v24, v24, v25
    v_cvt_pk_bf16_f32 v25, v26, v27
    v_mul_f32 v173, 0x3eb8aa3b, v173
    v_cvt_pk_bf16_f32 v60, v60, v61
    v_cvt_pk_bf16_f32 v61, v62, v63
    v_pk_fma_f32 v[64:65], v[156:157], v[174:175], v[64:65] op_sel_hi:[1,0,1]
    v_pk_fma_f32 v[66:67], v[158:159], v[174:175], v[66:67] op_sel_hi:[1,0,1]
    v_pk_fma_f32 v[28:29], v[152:153], v[174:175], v[28:29] op_sel_hi:[1,0,1]
    v_pk_fma_f32 v[30:31], v[154:155], v[174:175], v[30:31] op_sel_hi:[1,0,1]
    v_pk_mul_f32 v[64:65], v[64:65], v[174:175] op_sel:[0,1] op_sel_hi:[1,1]
    v_pk_mul_f32 v[66:67], v[66:67], v[174:175] op_sel:[0,1] op_sel_hi:[1,1]
    v_cvt_pk_bf16_f32 v28, v28, v29
    v_cvt_pk_bf16_f32 v29, v30, v31
    v_mul_f32 v175, 0x3eb8aa3b, v175
    s_add_u32 m0, s96, 96256
    s_add_u32 s53, s59, 131072
    s_waitcnt lgkmcnt(8)
    buffer_load_dwordx4 v218, s[60:63], s53 offen offset:0 lds
    buffer_load_dwordx4 v219, s[60:63], s53 offen offset:1024 lds
    s_add_u32 m0, s96, 98304
    s_add_u32 s53, s59, 147456
    buffer_load_dwordx4 v218, s[60:63], s53 offen offset:0 lds
    buffer_load_dwordx4 v219, s[60:63], s53 offen offset:1024 lds
    s_waitcnt vmcnt(22)
    ds_read_b64_tr_b16 a[66:67], v222 offset:4096
    ds_read_b64_tr_b16 a[70:71], v223 offset:4096
    ds_read_b64_tr_b16 a[74:75], v222 offset:4608
    ds_read_b64_tr_b16 a[78:79], v223 offset:4608
    ds_read_b64_tr_b16 a[80:81], v222 offset:6144
    ds_read_b64_tr_b16 a[84:85], v223 offset:6144
    ds_read_b64_tr_b16 a[88:89], v222 offset:6656
    ds_read_b64_tr_b16 a[92:93], v223 offset:6656
    v_cvt_pk_bf16_f32 v64, v64, v65
    v_cvt_pk_bf16_f32 v65, v66, v67
    v_pk_fma_f32 v[68:69], v[156:157], v[176:177], v[68:69] op_sel_hi:[1,0,1]
    v_pk_fma_f32 v[70:71], v[158:159], v[176:177], v[70:71] op_sel_hi:[1,0,1]
    v_pk_mul_f32 v[68:69], v[68:69], v[176:177] op_sel:[0,1] op_sel_hi:[1,1]
    v_pk_mul_f32 v[70:71], v[70:71], v[176:177] op_sel:[0,1] op_sel_hi:[1,1]
    v_cvt_pk_bf16_f32 v68, v68, v69
    v_cvt_pk_bf16_f32 v69, v70, v71
    v_pk_fma_f32 v[72:73], v[186:187], v[32:33], v[72:73]
    v_pk_fma_f32 v[74:75], v[188:189], v[32:33], v[74:75]
    v_pk_mul_f32 v[72:73], v[72:73], v[190:191]
    v_pk_mul_f32 v[74:75], v[74:75], v[192:193]
    v_cvt_pk_bf16_f32 v110, v72, v73
    v_cvt_pk_bf16_f32 v111, v74, v75
    v_pk_fma_f32 v[76:77], v[194:195], v[32:33], v[76:77]
    v_pk_fma_f32 v[78:79], v[196:197], v[32:33], v[78:79]
    v_pk_mul_f32 v[76:77], v[76:77], v[198:199]
    v_pk_mul_f32 v[78:79], v[78:79], v[200:201]
    ds_read_b128 v[186:189], v178 offset:256
    ds_read_b128 v[190:193], v178 offset:1280
    ds_read_b128 v[194:197], v178 offset:320
    ds_read_b128 v[198:201], v178 offset:1344
    v_cvt_pk_bf16_f32 v120, v76, v77
    v_cvt_pk_bf16_f32 v121, v78, v79
    v_pk_fma_f32 v[80:81], v[202:203], v[32:33], v[80:81]
    v_pk_fma_f32 v[82:83], v[204:205], v[32:33], v[82:83]
    v_pk_mul_f32 v[80:81], v[80:81], v[206:207]
    v_pk_mul_f32 v[82:83], v[82:83], v[208:209]
    v_cvt_pk_bf16_f32 v112, v80, v81
    v_cvt_pk_bf16_f32 v113, v82, v83
    v_pk_fma_f32 v[84:85], v[210:211], v[32:33], v[84:85]
    v_pk_fma_f32 v[86:87], v[212:213], v[32:33], v[86:87]
    v_pk_mul_f32 v[84:85], v[84:85], v[214:215]
    v_pk_mul_f32 v[86:87], v[86:87], v[216:217]
    ds_read_b128 v[202:205], v178 offset:384
    ds_read_b128 v[206:209], v178 offset:1408
    ds_read_b128 v[210:213], v178 offset:448
    ds_read_b128 v[214:217], v178 offset:1472
    v_cvt_pk_bf16_f32 v122, v84, v85
    s_add_u32 m0, s96, 0
    s_add_u32 s53, s81, 131072
    s_waitcnt lgkmcnt(14)
    buffer_load_dwordx4 v218, s[60:63], s53 offen offset:0 lds
    buffer_load_dwordx4 v219, s[60:63], s53 offen offset:1024 lds
    s_add_u32 m0, s96, 2048
    s_add_u32 s53, s81, 147456
    buffer_load_dwordx4 v218, s[60:63], s53 offen offset:0 lds
    buffer_load_dwordx4 v219, s[60:63], s53 offen offset:1024 lds
    s_waitcnt vmcnt(22)
    ds_read_b64_tr_b16 a[82:83], v222 offset:8192
    ds_read_b64_tr_b16 a[86:87], v223 offset:8192
    ds_read_b64_tr_b16 a[90:91], v222 offset:8704
    ds_read_b64_tr_b16 a[94:95], v223 offset:8704
    ds_read_b64_tr_b16 a[96:97], v222 offset:45056
    ds_read_b64_tr_b16 a[100:101], v223 offset:45056
    ds_read_b64_tr_b16 a[104:105], v222 offset:45568
    ds_read_b64_tr_b16 a[108:109], v223 offset:45568
    v_cvt_pk_bf16_f32 v123, v86, v87
    s_waitcnt lgkmcnt(14)
    v_pk_fma_f32 v[88:89], v[186:187], v[32:33], v[88:89]
    v_pk_fma_f32 v[90:91], v[188:189], v[32:33], v[90:91]
    v_pk_mul_f32 v[88:89], v[88:89], v[190:191]
    v_pk_mul_f32 v[90:91], v[90:91], v[192:193]
    ds_read_b128 v[186:189], v178 offset:512
    ds_read_b128 v[190:193], v178 offset:1536
    v_cvt_pk_bf16_f32 v114, v88, v89
    v_cvt_pk_bf16_f32 v115, v90, v91
    s_waitcnt lgkmcnt(14)
    v_pk_fma_f32 v[92:93], v[194:195], v[32:33], v[92:93]
    v_pk_fma_f32 v[94:95], v[196:197], v[32:33], v[94:95]
    v_pk_mul_f32 v[92:93], v[92:93], v[198:199]
    v_pk_mul_f32 v[94:95], v[94:95], v[200:201]
    v_cvt_pk_bf16_f32 v124, v92, v93
    v_cvt_pk_bf16_f32 v125, v94, v95
    s_waitcnt lgkmcnt(13)
    v_pk_fma_f32 v[96:97], v[202:203], v[32:33], v[96:97]
    v_pk_fma_f32 v[98:99], v[204:205], v[32:33], v[98:99]
    s_waitcnt lgkmcnt(12)
    v_pk_mul_f32 v[96:97], v[96:97], v[206:207]
    v_pk_mul_f32 v[98:99], v[98:99], v[208:209]
    v_cvt_pk_bf16_f32 v116, v96, v97
    v_cvt_pk_bf16_f32 v117, v98, v99
    s_waitcnt lgkmcnt(11)
    v_pk_fma_f32 v[100:101], v[210:211], v[32:33], v[100:101]
    v_pk_fma_f32 v[102:103], v[212:213], v[32:33], v[102:103]
    s_waitcnt lgkmcnt(10)
    v_pk_mul_f32 v[100:101], v[100:101], v[214:215]
    v_pk_mul_f32 v[102:103], v[102:103], v[216:217]
    v_cvt_pk_bf16_f32 v126, v100, v101
    v_cvt_pk_bf16_f32 v127, v102, v103
    s_waitcnt lgkmcnt(1)
    v_pk_fma_f32 v[104:105], v[186:187], v[32:33], v[104:105]
    v_pk_fma_f32 v[106:107], v[188:189], v[32:33], v[106:107]
    s_waitcnt lgkmcnt(0)
    v_pk_mul_f32 v[104:105], v[104:105], v[190:191]
    v_pk_mul_f32 v[106:107], v[106:107], v[192:193]
    v_cvt_pk_bf16_f32 v108, v104, v105
    v_cvt_pk_bf16_f32 v109, v106, v107
    v_mov_b32 v118, v108
    v_mov_b32_e64 v119, v109
    v_mfma_f32_16x16x16_bf16 v[72:75], v[36:37], v[0:1], v[128:131]
    v_mfma_f32_16x16x16_bf16 v[186:189], v[68:69], v[0:1], v[136:139]
    s_add_u32 m0, s96, 4096
    s_add_u32 s53, s94, 131072
    buffer_load_dwordx4 v218, s[60:63], s53 offen offset:0 lds
    buffer_load_dwordx4 v219, s[60:63], s53 offen offset:1024 lds
    s_add_u32 m0, s96, 6144
    s_add_u32 s53, s94, 147456
    buffer_load_dwordx4 v218, s[60:63], s53 offen offset:0 lds
    buffer_load_dwordx4 v219, s[60:63], s53 offen offset:1024 lds
    s_waitcnt vmcnt(22)
    ds_read_b64_tr_b16 a[98:99], v222 offset:47104
    ds_read_b64_tr_b16 a[102:103], v223 offset:47104
    ds_read_b64_tr_b16 a[106:107], v222 offset:47616
    ds_read_b64_tr_b16 a[110:111], v223 offset:47616
    ds_read_b64_tr_b16 a[112:113], v222 offset:49152
    ds_read_b64_tr_b16 a[116:117], v223 offset:49152
    ds_read_b64_tr_b16 a[120:121], v222 offset:49664
    ds_read_b64_tr_b16 a[124:125], v223 offset:49664
    v_mfma_f32_16x16x16_bf16 v[76:79], v[40:41], v[4:5], v[128:131]
    v_mfma_f32_16x16x16_bf16 v[190:193], v[68:69], v[4:5], v[140:143]
    v_mfma_f32_16x16x16_bf16 v[80:83], v[44:45], v[8:9], v[128:131]
    v_mfma_f32_16x16x16_bf16 v[194:197], v[36:37], v[8:9], v[132:135]
    v_mfma_f32_16x16x16_bf16 v[84:87], v[48:49], v[12:13], v[128:131]
    v_mfma_f32_16x16x16_bf16 v[198:201], v[40:41], v[12:13], v[132:135]
    v_mfma_f32_16x16x16_bf16 v[88:91], v[52:53], v[16:17], v[128:131]
    v_mfma_f32_16x16x16_bf16 v[202:205], v[44:45], v[16:17], v[132:135]
    v_max_f32 v72, v72, v186
    v_max_f32 v73, v73, v187
    v_max_f32 v74, v74, v188
    v_max_f32_e64 v75, v75, v189
    v_mfma_f32_16x16x16_bf16 v[92:95], v[56:57], v[20:21], v[128:131]
    v_mfma_f32_16x16x16_bf16 v[206:209], v[48:49], v[20:21], v[132:135]
    v_max_f32 v76, v76, v190
    v_max_f32 v77, v77, v191
    v_max_f32 v78, v78, v192
    v_max_f32 v79, v79, v193
    v_mfma_f32_16x16x16_bf16 v[96:99], v[60:61], v[24:25], v[128:131]
    v_mfma_f32_16x16x16_bf16 v[210:213], v[52:53], v[24:25], v[132:135]
    v_max_f32 v80, v80, v194
    v_max_f32 v81, v81, v195
    v_max_f32 v82, v82, v196
    v_max_f32 v83, v83, v197
    v_mfma_f32_16x16x16_bf16 v[100:103], v[64:65], v[28:29], v[128:131]
    v_mfma_f32_16x16x16_bf16 v[214:217], v[56:57], v[28:29], v[132:135]
    v_max_f32 v84, v84, v198
    v_max_f32 v85, v85, v199
    v_max_f32 v86, v86, v200
    v_max_f32 v87, v87, v201
    v_max_f32 v88, v88, v202
    v_max_f32 v89, v89, v203
    v_max_f32 v90, v90, v204
    v_max_f32 v91, v91, v205
    v_max_f32_e64 v92, v92, v206
    s_add_u32 m0, s96, 8192
    s_add_u32 s53, s95, 131072
    buffer_load_dwordx4 v218, s[60:63], s53 offen offset:0 lds
    buffer_load_dwordx4 v219, s[60:63], s53 offen offset:1024 lds
    s_add_u32 m0, s96, 45056
    s_add_u32 s53, s95, 147456
    buffer_load_dwordx4 v218, s[60:63], s53 offen offset:0 lds
    buffer_load_dwordx4 v219, s[60:63], s53 offen offset:1024 lds
    s_waitcnt vmcnt(22)
    ds_read_b64_tr_b16 a[114:115], v222 offset:51200
    ds_read_b64_tr_b16 a[118:119], v223 offset:51200
    ds_read_b64_tr_b16 a[122:123], v222 offset:51712
    ds_read_b64_tr_b16 a[126:127], v223 offset:51712
    ds_read_b64_tr_b16 a[128:129], v222 offset:53248
    ds_read_b64_tr_b16 a[132:133], v223 offset:53248
    ds_read_b64_tr_b16 a[136:137], v222 offset:53760
    ds_read_b64_tr_b16 a[140:141], v223 offset:53760
    v_max_f32 v93, v93, v207
    v_max_f32 v94, v94, v208
    v_max_f32 v95, v95, v209
    v_max_f32 v96, v96, v210
    v_max_f32 v97, v97, v211
    v_max_f32 v98, v98, v212
    v_max_f32 v99, v99, v213
    v_max_f32 v100, v100, v214
    v_max_f32 v101, v101, v215
    v_max_f32 v102, v102, v216
    v_max_f32 v103, v103, v217
    v_max3_f32 v2, v72, v73, v74
    v_max3_f32 v6, v76, v77, v78
    v_max3_f32 v10, v80, v81, v82
    v_max3_f32 v14, v84, v85, v86
    v_max3_f32 v18, v88, v89, v90
    v_max3_f32 v22, v92, v93, v94
    v_max3_f32 v26, v96, v97, v98
    v_max3_f32 v30, v100, v101, v102
    v_max_f32 v2, v2, v75
    v_max_f32 v6, v6, v79
    v_max_f32 v10, v10, v83
    v_max_f32 v14, v14, v87
    v_max_f32 v18, v18, v91
    v_max_f32 v22, v22, v95
    v_max_f32 v26, v26, v99
    v_max_f32 v30, v30, v103
    v_permlane32_swap_b32 v2, v6
    v_permlane32_swap_b32 v10, v14
    v_permlane32_swap_b32 v18, v22
    v_permlane32_swap_b32 v26, v30
    v_max_f32 v2, v2, v6
    v_max_f32 v10, v10, v14
    v_max_f32 v18, v18, v22
    v_max_f32 v26, v26, v30
    s_add_u32 m0, s96, 47104
    s_xor_b32 s53, s57, 0
    s_waitcnt lgkmcnt(8)
    buffer_load_dwordx4 v220, s[64:67], s53 offen offset:0 lds
    buffer_load_dwordx4 v221, s[64:67], s53 offen offset:1024 lds
    s_add_u32 m0, s96, 49152
    s_xor_b32 s53, s57, 4096
    buffer_load_dwordx4 v220, s[64:67], s53 offen offset:0 lds
    buffer_load_dwordx4 v221, s[64:67], s53 offen offset:1024 lds
    s_waitcnt vmcnt(22)
    ds_read_b64_tr_b16 a[130:131], v224 offset:0
    ds_read_b64_tr_b16 a[134:135], v225 offset:0
    ds_read_b64_tr_b16 a[138:139], v224 offset:512
    ds_read_b64_tr_b16 a[142:143], v225 offset:512
    ds_read_b64_tr_b16 a[144:145], v224 offset:2048
    ds_read_b64_tr_b16 a[148:149], v225 offset:2048
    ds_read_b64_tr_b16 a[152:153], v224 offset:2560
    ds_read_b64_tr_b16 a[156:157], v225 offset:2560
    v_permlane16_swap_b32 v2, v10
    v_permlane16_swap_b32 v18, v26
    v_max_f32 v2, v2, v10
    v_max_f32 v18, v18, v26
    v_mov_b32 v10, v2
    v_mov_b32 v26, v18
    s_nop 0
    v_permlane16_swap_b32 v2, v10
    v_permlane16_swap_b32 v18, v26
    v_mov_b32 v6, v2
    v_mov_b32 v14, v10
    v_mov_b32 v22, v18
    v_mov_b32 v30, v26
    v_permlane32_swap_b32 v2, v6
    v_permlane32_swap_b32 v10, v14
    v_permlane32_swap_b32 v18, v22
    v_permlane32_swap_b32 v26, v30
    v_mul_f32_e64 v160, -v2, v161
    v_mul_f32_e64 v162, -v6, v163
    v_mul_f32_e64 v164, -v10, v165
    v_mul_f32_e64 v166, -v14, v167
    v_mul_f32_e64 v168, -v18, v169
    v_mul_f32_e64 v170, -v22, v171
    v_mul_f32_e64 v172, -v26, v173
    v_mul_f32_e64 v174, -v30, v175
    v_pk_fma_f32 v[72:73], v[72:73], v[160:161], v[160:161] op_sel:[0,1,0] op_sel_hi:[1,1,0]
    v_pk_fma_f32 v[74:75], v[74:75], v[160:161], v[160:161] op_sel:[0,1,0] op_sel_hi:[1,1,0]
    v_pk_fma_f32 v[76:77], v[76:77], v[162:163], v[162:163] op_sel:[0,1,0] op_sel_hi:[1,1,0]
    v_pk_fma_f32 v[78:79], v[78:79], v[162:163], v[162:163] op_sel:[0,1,0] op_sel_hi:[1,1,0]
    v_pk_fma_f32 v[80:81], v[80:81], v[164:165], v[164:165] op_sel:[0,1,0] op_sel_hi:[1,1,0]
    v_pk_fma_f32 v[82:83], v[82:83], v[164:165], v[164:165] op_sel:[0,1,0] op_sel_hi:[1,1,0]
    v_pk_fma_f32 v[84:85], v[84:85], v[166:167], v[166:167] op_sel:[0,1,0] op_sel_hi:[1,1,0]
    v_pk_fma_f32 v[86:87], v[86:87], v[166:167], v[166:167] op_sel:[0,1,0] op_sel_hi:[1,1,0]
    v_pk_fma_f32 v[88:89], v[88:89], v[168:169], v[168:169] op_sel:[0,1,0] op_sel_hi:[1,1,0]
    v_pk_fma_f32 v[90:91], v[90:91], v[168:169], v[168:169] op_sel:[0,1,0] op_sel_hi:[1,1,0]
    v_pk_fma_f32 v[92:93], v[92:93], v[170:171], v[170:171] op_sel:[0,1,0] op_sel_hi:[1,1,0]
    s_add_u32 m0, s96, 51200
    s_xor_b32 s53, s57, 32768
    s_waitcnt lgkmcnt(8)
    buffer_load_dwordx4 v220, s[64:67], s53 offen offset:0 lds
    buffer_load_dwordx4 v221, s[64:67], s53 offen offset:1024 lds
    s_add_u32 m0, s96, 53248
    s_xor_b32 s53, s57, 36864
    buffer_load_dwordx4 v220, s[64:67], s53 offen offset:0 lds
    buffer_load_dwordx4 v221, s[64:67], s53 offen offset:1024 lds
    s_waitcnt vmcnt(22)
    ds_read_b64_tr_b16 a[146:147], v224 offset:4096
    ds_read_b64_tr_b16 a[150:151], v225 offset:4096
    ds_read_b64_tr_b16 a[154:155], v224 offset:4608
    ds_read_b64_tr_b16 a[158:159], v225 offset:4608
    ds_read_b64_tr_b16 a[160:161], v224 offset:6144
    ds_read_b64_tr_b16 a[164:165], v225 offset:6144
    ds_read_b64_tr_b16 a[168:169], v224 offset:6656
    ds_read_b64_tr_b16 a[172:173], v225 offset:6656
    v_pk_fma_f32 v[94:95], v[94:95], v[170:171], v[170:171] op_sel:[0,1,0] op_sel_hi:[1,1,0]
    v_pk_fma_f32 v[96:97], v[96:97], v[172:173], v[172:173] op_sel:[0,1,0] op_sel_hi:[1,1,0]
    v_pk_fma_f32 v[98:99], v[98:99], v[172:173], v[172:173] op_sel:[0,1,0] op_sel_hi:[1,1,0]
    v_pk_fma_f32 v[100:101], v[100:101], v[174:175], v[174:175] op_sel:[0,1,0] op_sel_hi:[1,1,0]
    v_pk_fma_f32 v[102:103], v[102:103], v[174:175], v[174:175] op_sel:[0,1,0] op_sel_hi:[1,1,0]
    v_exp_f32 v72, v72
    v_exp_f32 v73, v73
    v_exp_f32 v74, v74
    v_exp_f32 v75, v75
    v_exp_f32 v76, v76
    v_exp_f32 v77, v77
    v_exp_f32 v78, v78
    v_exp_f32 v79, v79
    v_exp_f32 v80, v80
    v_exp_f32 v81, v81
    v_exp_f32 v82, v82
    v_exp_f32 v83, v83
    v_exp_f32 v84, v84
    v_exp_f32 v85, v85
    v_exp_f32 v86, v86
    v_exp_f32 v87, v87
    v_exp_f32 v88, v88
    v_exp_f32 v89, v89
    v_exp_f32 v90, v90
    v_exp_f32 v91, v91
    v_exp_f32 v92, v92
    v_exp_f32 v93, v93
    v_exp_f32 v94, v94
    v_exp_f32 v95, v95
    v_exp_f32 v96, v96
    v_exp_f32 v97, v97
    v_exp_f32 v98, v98
    v_exp_f32 v99, v99
    v_exp_f32 v100, v100
    v_exp_f32 v101, v101
    s_add_u32 m0, s96, 90112
    s_xor_b32 s53, s57, 65536
    s_waitcnt lgkmcnt(8)
    buffer_load_dwordx4 v220, s[64:67], s53 offen offset:0 lds
    buffer_load_dwordx4 v221, s[64:67], s53 offen offset:1024 lds
    s_add_u32 m0, s96, 92160
    s_xor_b32 s53, s57, 69632
    buffer_load_dwordx4 v220, s[64:67], s53 offen offset:0 lds
    buffer_load_dwordx4 v221, s[64:67], s53 offen offset:1024 lds
    s_waitcnt vmcnt(24)
    ds_read_b64_tr_b16 a[162:163], v224 offset:8192
    ds_read_b64_tr_b16 a[166:167], v225 offset:8192
    ds_read_b64_tr_b16 a[170:171], v224 offset:8704
    ds_read_b64_tr_b16 a[174:175], v225 offset:8704
    v_exp_f32 v102, v102
    v_exp_f32 v103, v103
    v_cvt_pk_bf16_f32 v72, v72, v73
    v_cvt_pk_bf16_f32 v73, v74, v75
    v_cvt_pk_bf16_f32 v76, v76, v77
    v_cvt_pk_bf16_f32 v77, v78, v79
    v_cvt_pk_bf16_f32 v80, v80, v81
    v_cvt_pk_bf16_f32 v81, v82, v83
    v_cvt_pk_bf16_f32 v84, v84, v85
    v_cvt_pk_bf16_f32 v85, v86, v87
    v_cvt_pk_bf16_f32 v88, v88, v89
    v_cvt_pk_bf16_f32 v89, v90, v91
    v_cvt_pk_bf16_f32 v92, v92, v93
    v_cvt_pk_bf16_f32 v93, v94, v95
    v_cvt_pk_bf16_f32 v96, v96, v97
    v_cvt_pk_bf16_f32 v97, v98, v99
    v_cvt_pk_bf16_f32 v100, v100, v101
    v_cvt_pk_bf16_f32 v101, v102, v103
    v_mfma_f32_16x16x16_bf16 v[36:39], v[148:149], v[72:73], 0
    v_and_b32 v186, v146, v72
    v_and_b32 v187, v147, v73
    v_and_b32 v188, v144, v72
    v_and_b32 v189, v145, v73
    v_mfma_f32_16x16x16_bf16 v[40:43], v[148:149], v[76:77], 0
    v_and_b32 v190, v146, v76
    v_and_b32 v191, v147, v77
    v_mfma_f32_16x16x32_bf16 v[0:3], v[108:111], v[186:189], 0
    v_and_b32 v192, v144, v76
    v_and_b32 v193, v145, v77
    v_mfma_f32_16x16x16_bf16 v[44:47], v[148:149], v[80:81], 0
    v_and_b32 v194, v146, v80
    v_and_b32 v195, v147, v81
    v_mfma_f32_16x16x32_bf16 v[4:7], v[118:121], v[190:193], 0
    v_and_b32 v196, v144, v80
    v_and_b32 v197, v145, v81
    buffer_load_dword v246, v251, s[36:39], s42 offen sc1
    s_add_u32 m0, s96, 94208
    s_xor_b32 s53, s57, 98304
    s_waitcnt lgkmcnt(4)
    buffer_load_dwordx4 v220, s[64:67], s53 offen offset:0 lds
    buffer_load_dwordx4 v221, s[64:67], s53 offen offset:1024 lds
    s_add_u32 m0, s96, 96256
    s_xor_b32 s53, s57, 102400
    buffer_load_dwordx4 v220, s[64:67], s53 offen offset:0 lds
    buffer_load_dwordx4 v221, s[64:67], s53 offen offset:1024 lds
    v_mfma_f32_16x16x16_bf16 v[48:51], v[148:149], v[84:85], 0
    v_and_b32 v198, v146, v84
    v_and_b32 v199, v147, v85
    v_mfma_f32_16x16x32_bf16 v[8:11], v[110:113], v[194:197], 0
    v_and_b32 v200, v144, v84
    v_and_b32 v201, v145, v85
    v_mfma_f32_16x16x16_bf16 v[52:55], v[148:149], v[88:89], 0
    v_and_b32 v202, v146, v88
    v_and_b32 v203, v147, v89
    v_mfma_f32_16x16x32_bf16 v[12:15], v[120:123], v[198:201], 0
    v_and_b32 v204, v144, v88
    v_and_b32 v205, v145, v89
    v_mfma_f32_16x16x16_bf16 v[56:59], v[148:149], v[92:93], 0
    v_and_b32 v206, v146, v92
    v_and_b32 v207, v147, v93
    v_mfma_f32_16x16x32_bf16 v[16:19], v[112:115], v[202:205], 0
    v_and_b32 v208, v144, v92
    v_and_b32 v209, v145, v93
    v_mfma_f32_16x16x16_bf16 v[60:63], v[148:149], v[96:97], 0
    v_and_b32 v210, v146, v96
    v_and_b32 v211, v147, v97
    v_mfma_f32_16x16x32_bf16 v[20:23], v[122:125], v[206:209], 0
    v_and_b32 v212, v144, v96
    v_and_b32 v213, v145, v97
    v_mfma_f32_16x16x16_bf16 v[64:67], v[148:149], v[100:101], 0
    v_and_b32 v214, v146, v100
    v_and_b32 v215, v147, v101
    v_mfma_f32_16x16x32_bf16 v[24:27], v[114:117], v[210:213], 0
    v_and_b32 v216, v144, v100
    v_and_b32 v217, v145, v101
    v_rcp_f32 v36, v36
    v_rcp_f32 v40, v40
    v_mfma_f32_16x16x32_bf16 v[28:31], v[124:127], v[214:217], 0
    v_rcp_f32 v44, v44
    v_rcp_f32_e64 v48, v48
    s_mov_b32 m0, s58
    s_nop 0
    buffer_load_dword v228, s[76:79], s49 offen offset:2048 lds
    buffer_load_dwordx4 v247, s[68:71], s43 offen offset:0 lds
    buffer_load_dwordx4 v249, s[68:71], s43 offen offset:1024 lds
    v_rcp_f32 v52, v52
    v_rcp_f32 v56, v56
    v_rcp_f32 v60, v60
    v_rcp_f32 v64, v64
    v_pk_mul_f32 v[0:1], v[0:1], v[36:37] op_sel_hi:[1,0]
    v_pk_mul_f32 v[2:3], v[2:3], v[36:37] op_sel_hi:[1,0]
    v_pk_mul_f32 v[4:5], v[4:5], v[40:41] op_sel_hi:[1,0]
    v_pk_mul_f32 v[6:7], v[6:7], v[40:41] op_sel_hi:[1,0]
    v_pk_mul_f32 v[8:9], v[8:9], v[44:45] op_sel_hi:[1,0]
    v_pk_mul_f32 v[10:11], v[10:11], v[44:45] op_sel_hi:[1,0]
    v_pk_mul_f32 v[12:13], v[12:13], v[48:49] op_sel_hi:[1,0]
    v_pk_mul_f32 v[14:15], v[14:15], v[48:49] op_sel_hi:[1,0]
    v_pk_mul_f32 v[16:17], v[16:17], v[52:53] op_sel_hi:[1,0]
    v_pk_mul_f32 v[18:19], v[18:19], v[52:53] op_sel_hi:[1,0]
    v_pk_mul_f32 v[20:21], v[20:21], v[56:57] op_sel_hi:[1,0]
    v_pk_mul_f32 v[22:23], v[22:23], v[56:57] op_sel_hi:[1,0]
    v_pk_mul_f32 v[24:25], v[24:25], v[60:61] op_sel_hi:[1,0]
    v_pk_mul_f32 v[26:27], v[26:27], v[60:61] op_sel_hi:[1,0]
    v_pk_mul_f32 v[28:29], v[28:29], v[64:65] op_sel_hi:[1,0]
    v_pk_mul_f32 v[30:31], v[30:31], v[64:65] op_sel_hi:[1,0]
    v_cvt_pk_bf16_f32 v72, v0, v1
    v_cvt_pk_bf16_f32 v73, v2, v3
    v_cvt_pk_bf16_f32 v74, v4, v5
    v_cvt_pk_bf16_f32 v75, v6, v7
    v_cvt_pk_bf16_f32 v76, v8, v9
    v_cvt_pk_bf16_f32 v77, v10, v11
    v_cvt_pk_bf16_f32 v78, v12, v13
    v_cvt_pk_bf16_f32 v79, v14, v15
    v_cvt_pk_bf16_f32 v80, v16, v17
    v_cvt_pk_bf16_f32 v81, v18, v19
    v_cvt_pk_bf16_f32 v82, v20, v21
    v_cvt_pk_bf16_f32 v83, v22, v23
    v_cvt_pk_bf16_f32 v84, v24, v25
    v_cvt_pk_bf16_f32 v85, v26, v27
    v_cvt_pk_bf16_f32 v86, v28, v29
    v_cvt_pk_bf16_f32 v87, v30, v31
    v_permlane16_swap_b32 v72, v74
    v_permlane16_swap_b32 v73, v75
    v_permlane16_swap_b32 v76, v78
    v_permlane16_swap_b32 v77, v79
    v_permlane16_swap_b32 v80, v82
    v_permlane16_swap_b32 v81, v83
    v_permlane16_swap_b32 v84, v86
    v_permlane16_swap_b32 v85, v87
    buffer_store_dwordx4 v[72:75], v179, s[36:39], s97 offen sc1
    s_add_u32 s87, s97, 2048
    buffer_store_dwordx4 v[76:79], v179, s[36:39], s87 offen sc1
    s_add_u32 s87, s97, 294912
    buffer_store_dwordx4 v[80:83], v179, s[36:39], s87 offen sc1
    s_add_u32 s87, s97, 296960
    buffer_store_dwordx4 v[84:87], v179, s[36:39], s87 offen sc1
    s_waitcnt vmcnt(11)
    v_cmp_le_u32 vcc, 1, v246
    s_nop 1
    s_cmp_eq_u64 vcc, -1
    s_cbranch_scc0 L_atpe_spin
L_atpe_ok:
    s_add_u32 s42, s42, 0x20000
    buffer_load_dwordx4 a[176:179], v232, s[36:39], s0 offen sc1
    buffer_load_dwordx4 a[180:183], v232, s[36:39], s1 offen sc1
    buffer_load_dwordx4 a[184:187], v231, s[36:39], s0 offen sc1
    buffer_load_dwordx4 a[188:191], v231, s[36:39], s1 offen sc1
    buffer_load_dwordx4 a[192:195], v230, s[36:39], s0 offen sc1
    buffer_load_dwordx4 a[196:199], v230, s[36:39], s1 offen sc1
    buffer_load_dwordx4 a[200:203], v229, s[36:39], s0 offen sc1
    buffer_load_dwordx4 a[204:207], v229, s[36:39], s1 offen sc1
    s_waitcnt vmcnt(8)
    buffer_store_dword v240, v248, s[36:39], s98 offen sc1
    buffer_load_dwordx4 a[208:211], v232, s[36:39], s10 offen sc1
    buffer_load_dwordx4 a[212:215], v232, s[36:39], s11 offen sc1
    buffer_load_dwordx4 a[216:219], v231, s[36:39], s10 offen sc1
    buffer_load_dwordx4 a[220:223], v231, s[36:39], s11 offen sc1
    s_branch L_p2
.p2alignl 12, 0xbf810000
.fill 736, 4, 0xbf810000
R_ff:
L_ffn:
    v_and_b32 v30, 15, v255
    v_lshrrev_b32 v31, 1, v30
    v_xor_b32 v31, v4, v31
    v_lshlrev_b32 v31, 4, v31
    v_lshl_add_u32 v31, v30, 7, v31
    s_lshr_b32 s88, s82, 1
    s_and_b32 s89, s82, 1
    s_mul_i32 s87, s88, 22528
    v_add_u32 v144, s87, v31
    v_xor_b32 v145, 64, v144
    v_add_u32 v146, 90112, v144
    v_add_u32 v147, 90112, v145
    v_mul_u32_u24 v31, 11264, v6
    v_lshl_add_u32 v31, v5, 3, v31
    v_lshl_add_u32 v31, v7, 6, v31
    v_lshl_add_u32 v31, v20, 5, v31
    s_lshl_b32 s87, s89, 9
    v_lshl_add_u32 v148, v20, 10, v31
    v_add_u32 v148, s87, v148
    v_xor_b32 v149, 32, v148
    s_lshl_b32 s87, s89, 5
    v_lshl_add_u32 v150, v20, 9, v31
    v_xor_b32_e64 v150, s87, v150
    v_add_u32 v151, 45056, v148
    v_add_u32 v152, 45056, v149
    v_add_u32 v153, 45056, v150
    v_add_u32 v154, 90112, v148
    v_add_u32 v155, 90112, v149
    v_add_u32 v156, 90112, v150
    s_and_b32 s55, s84, 1
    v_lshlrev_b32 v31, 1, v4
    v_min_u32 v31, 3, v31
    v_lshlrev_b32 v31, 8, v31
    v_lshl_add_u32 v31, v30, 2, v31
    s_mul_i32 s87, s55, 10
    s_add_u32 s87, s87, s89
    s_lshl_b32 s87, s87, 7
    s_add_u32 s87, s87, 135168
    v_add_u32 v140, s87, v31
    v_add_u32 v141, 64, v140
    s_cmp_eq_u32 s55, 0
    s_cselect_b32 s87, 60, 2
    s_add_u32 s87, s87, s89
    s_lshl_b32 s87, s87, 6
    s_add_u32 s87, s87, 135168
    v_add_u32 v142, s87, v31
    s_cmp_eq_u32 s82, 3
    s_cselect_b32 s87, 1073741824, 0
    v_or_b32 v157, s87, v254
    s_lshl_b32 s87, s88, 9
    s_add_u32 s87, s87, 140288
    v_lshl_add_u32 v159, v30, 4, s87
    s_and_b32 s87, s82, 1
    s_lshl_b32 s87, s87, 5
    v_lshl_add_u32 v31, v6, 4, v30
    v_add_lshl_u32 v31, v31, s87, 4
    v_mov_b32 v160, v31
    v_lshl_add_u32 v160, v20, 10, v160
    s_lshl_b32 s87, s83, 1
    s_add_u32 s87, s87, s88
    s_lshl_b32 s98, s87, 3
    s_add_u32 s98, s98, s84
    s_lshl_b32 s98, s98, 1
    s_add_u32 s98, s98, s89
    s_lshl_b32 s98, s98, 7
    s_add_u32 s98, s98, 10616832
    s_mul_i32 s87, s87, 72
    s_lshr_b32 s88, s84, 1
    s_mul_i32 s88, s88, 14
    s_add_u32 s87, s87, s88
    s_add_u32 s99, s87, s55
    s_lshl_b32 s99, s99, 12
    s_add_u32 s99, s99, 16891904
    s_lshl_b32 s88, s55, 1
    s_add_u32 s88, s88, s89
    s_mul_i32 s88, s88, 3
    s_add_u32 s87, s87, s88
    s_lshl_b32 s97, s87, 12
    s_add_u32 s97, s97, 16842752
    s_mul_i32 s90, s84, 7
    s_lshr_b32 s90, s90, 1
    s_mul_i32 s90, s90, 1280
    s_lshl_b32 s92, s82, 11
    s_add_u32 s90, s90, s92
    s_add_u32 s90, s90, 9568256
    s_lshl_b32 s91, s83, 10
    s_add_u32 s91, s91, 9436160
    s_cmp_eq_u32 s82, 2
    s_cselect_b32 s91, s91, s90
    s_add_u32 m0, s96, 45056
    s_nop 0
    buffer_load_dwordx4 v229, s[28:31], s51 offen offset:0 lds
    buffer_load_dwordx4 v230, s[28:31], s51 offen offset:1024 lds
    buffer_load_dwordx4 v231, s[28:31], s51 offen offset:2048 lds
    buffer_load_dwordx4 v232, s[28:31], s51 offen offset:3072 lds
    s_add_u32 m0, s96, 49152
    s_nop 0
    buffer_load_dwordx4 v233, s[32:35], s52 offen offset:0 lds
    buffer_load_dwordx4 v234, s[32:35], s52 offen offset:1024 lds
    s_waitcnt vmcnt(6)
    s_barrier
    ds_read_b64_tr_b16 a[200:201], v148 offset:5120
    ds_read_b64_tr_b16 a[202:203], v148 offset:5376
    ds_read_b64_tr_b16 a[204:205], v148 offset:27648
    ds_read_b64_tr_b16 a[206:207], v148 offset:27904
    ds_read_b128 a[136:139], v144 offset:0
    ds_read_b128 a[140:143], v145 offset:0
    ds_read_b128 a[144:147], v144 offset:2048
    ds_read_b128 a[148:151], v145 offset:2048
    ds_read_b128 a[152:155], v144 offset:11264
    ds_read_b128 a[156:159], v145 offset:11264
    ds_read_b128 a[160:163], v144 offset:13312
    ds_read_b128 a[164:167], v145 offset:13312
    ds_read_b64_tr_b16 a[208:209], v149 offset:5120
    ds_read_b64_tr_b16 a[210:211], v149 offset:5376
    ds_read_b64_tr_b16 a[212:213], v149 offset:27648
    ds_read_b64_tr_b16 a[214:215], v149 offset:27904
    ds_read_b64_tr_b16 a[216:217], v148 offset:7168
    ds_read_b64_tr_b16 a[218:219], v148 offset:7424
    ds_read_b64_tr_b16 a[220:221], v148 offset:29696
    ds_read_b64_tr_b16 a[222:223], v148 offset:29952
    buffer_load_dwordx4 v235, s[32:35], s52 offen offset:2048 lds
    buffer_load_dwordx4 v236, s[32:35], s52 offen offset:3072 lds
    s_add_u32 m0, s96, 53248
    s_nop 0
    buffer_load_dwordx4 v237, s[32:35], s52 offen offset:0 lds
    buffer_load_dwordx4 v238, s[32:35], s52 offen offset:1024 lds
    s_waitcnt lgkmcnt(8)
    v_mfma_f32_16x16x32_bf16 v[0:3], a[200:203], a[136:139], 0
    ds_read_b64_tr_b16 a[224:225], v149 offset:7168
    v_mfma_f32_16x16x32_bf16 v[0:3], a[204:207], a[140:143], v[0:3]
    ds_read_b64_tr_b16 a[226:227], v149 offset:7424
    v_mfma_f32_16x16x32_bf16 v[4:7], a[204:207], a[148:151], 0
    buffer_load_dwordx4 v239, s[32:35], s52 offen offset:2048 lds
    v_mfma_f32_16x16x32_bf16 v[4:7], a[200:203], a[144:147], v[4:7]
    ds_read_b64_tr_b16 a[228:229], v149 offset:29696
    ds_read_b64_tr_b16 a[230:231], v149 offset:29952
    v_mfma_f32_16x16x32_bf16 v[8:11], a[200:203], a[152:155], 0
    ds_read_b64_tr_b16 a[232:233], v148 offset:9216
    s_addk_i32 s51, 128
    v_mfma_f32_16x16x32_bf16 v[8:11], a[204:207], a[156:159], v[8:11]
    ds_read_b64_tr_b16 a[234:235], v148 offset:9472
    s_add_u32 s52, s52, s50
    v_mfma_f32_16x16x32_bf16 v[12:15], a[204:207], a[164:167], 0
    ds_read_b64_tr_b16 a[236:237], v148 offset:31744
    v_mfma_f32_16x16x32_bf16 v[12:15], a[200:203], a[160:163], v[12:15]
    ds_read_b64_tr_b16 a[238:239], v148 offset:32000
    s_waitcnt lgkmcnt(12)
    v_mfma_f32_16x16x32_bf16 v[28:31], a[208:211], a[160:163], 0
    ds_read_b64_tr_b16 a[240:241], v149 offset:9216
    s_add_u32 m0, s96, 90112
    v_mfma_f32_16x16x32_bf16 v[28:31], a[212:215], a[164:167], v[28:31]
    ds_read_b64_tr_b16 a[242:243], v149 offset:9472
    v_mfma_f32_16x16x32_bf16 v[24:27], a[212:215], a[156:159], 0
    ds_read_b64_tr_b16 a[244:245], v149 offset:31744
    v_mfma_f32_16x16x32_bf16 v[24:27], a[208:211], a[152:155], v[24:27]
    buffer_load_dwordx4 v229, s[28:31], s51 offen offset:0 lds
    v_mfma_f32_16x16x32_bf16 v[20:23], a[208:211], a[144:147], 0
    ds_read_b64_tr_b16 a[246:247], v149 offset:32000
    v_mfma_f32_16x16x32_bf16 v[20:23], a[212:215], a[148:151], v[20:23]
    ds_read_b64_tr_b16 a[248:249], v150 offset:4096
    ds_read_b64_tr_b16 a[250:251], v150 offset:4352
    v_mfma_f32_16x16x32_bf16 v[16:19], a[212:215], a[140:143], 0
    buffer_load_dwordx4 v230, s[28:31], s51 offen offset:1024 lds
    v_mfma_f32_16x16x32_bf16 v[16:19], a[208:211], a[136:139], v[16:19]
    ds_read_b64_tr_b16 a[252:253], v150 offset:26624
    s_waitcnt lgkmcnt(14)
    v_mfma_f32_16x16x32_bf16 v[32:35], a[216:219], a[136:139], 0
    ds_read_b64_tr_b16 a[254:255], v150 offset:26880
    v_mfma_f32_16x16x32_bf16 v[32:35], a[220:223], a[140:143], v[32:35]
    buffer_load_dwordx4 v231, s[28:31], s51 offen offset:2048 lds
    v_mfma_f32_16x16x32_bf16 v[36:39], a[220:223], a[148:151], 0
    buffer_load_dwordx4 v232, s[28:31], s51 offen offset:3072 lds
    v_mfma_f32_16x16x32_bf16 v[36:39], a[216:219], a[144:147], v[36:39]
    s_add_u32 m0, s96, 94208
    s_nop 0
    buffer_load_dwordx4 v233, s[32:35], s52 offen offset:0 lds
    v_mfma_f32_16x16x32_bf16 v[40:43], a[216:219], a[152:155], 0
    buffer_load_dwordx4 v234, s[32:35], s52 offen offset:1024 lds
    v_mfma_f32_16x16x32_bf16 v[40:43], a[220:223], a[156:159], v[40:43]
    buffer_load_dwordx4 v235, s[32:35], s52 offen offset:2048 lds
    v_mfma_f32_16x16x32_bf16 v[44:47], a[220:223], a[164:167], 0
    buffer_load_dwordx4 v236, s[32:35], s52 offen offset:3072 lds
    v_mfma_f32_16x16x32_bf16 v[44:47], a[216:219], a[160:163], v[44:47]
M_ff:
    s_waitcnt vmcnt(8) lgkmcnt(0)
    s_barrier
    v_mfma_f32_16x16x32_bf16 v[60:63], a[224:227], a[160:163], 0
    ds_read_b64_tr_b16 a[200:201], v151 offset:5120
    v_mfma_f32_16x16x32_bf16 v[60:63], a[228:231], a[164:167], v[60:63]
    ds_read_b64_tr_b16 a[202:203], v151 offset:5376
    s_add_u32 m0, s96, 98304
    v_mfma_f32_16x16x32_bf16 v[56:59], a[228:231], a[156:159], 0
    buffer_load_dwordx4 v237, s[32:35], s52 offen offset:0 lds
    v_mfma_f32_16x16x32_bf16 v[56:59], a[224:227], a[152:155], v[56:59]
    v_mfma_f32_16x16x32_bf16 v[52:55], a[224:227], a[144:147], 0
    ds_read_b64_tr_b16 a[204:205], v151 offset:27648
    v_mfma_f32_16x16x32_bf16 v[52:55], a[228:231], a[148:151], v[52:55]
    ds_read_b64_tr_b16 a[206:207], v151 offset:27904
    v_mfma_f32_16x16x32_bf16 v[48:51], a[228:231], a[140:143], 0
    buffer_load_dwordx4 v238, s[32:35], s52 offen offset:1024 lds
    v_mfma_f32_16x16x32_bf16 v[48:51], a[224:227], a[136:139], v[48:51]
    ds_read_b128 a[168:171], v144 offset:45056
    v_mfma_f32_16x16x32_bf16 v[64:67], a[232:235], a[136:139], 0
    buffer_load_dwordx4 v239, s[32:35], s52 offen offset:2048 lds
    v_mfma_f32_16x16x32_bf16 v[64:67], a[236:239], a[140:143], v[64:67]
    v_mfma_f32_16x16x32_bf16 v[68:71], a[236:239], a[148:151], 0
    ds_read_b128 a[172:175], v145 offset:45056
    v_mfma_f32_16x16x32_bf16 v[68:71], a[232:235], a[144:147], v[68:71]
    ds_read_b128 a[176:179], v144 offset:47104
    v_mfma_f32_16x16x32_bf16 v[72:75], a[232:235], a[152:155], 0
    s_addk_i32 s51, 128
    s_add_u32 s52, s52, s50
    v_mfma_f32_16x16x32_bf16 v[72:75], a[236:239], a[156:159], v[72:75]
    ds_read_b128 a[180:183], v145 offset:47104
    v_mfma_f32_16x16x32_bf16 v[76:79], a[236:239], a[164:167], 0
    ds_read_b128 a[184:187], v144 offset:56320
    s_add_u32 m0, s96, 0
    v_mfma_f32_16x16x32_bf16 v[76:79], a[232:235], a[160:163], v[76:79]
    ds_read_b128 a[188:191], v145 offset:56320
    v_mfma_f32_16x16x32_bf16 v[92:95], a[240:243], a[160:163], 0
    buffer_load_dwordx4 v229, s[28:31], s51 offen offset:0 lds
    v_mfma_f32_16x16x32_bf16 v[92:95], a[244:247], a[164:167], v[92:95]
    ds_read_b128 a[192:195], v144 offset:58368
    v_mfma_f32_16x16x32_bf16 v[88:91], a[244:247], a[156:159], 0
    ds_read_b128 a[196:199], v145 offset:58368
    v_mfma_f32_16x16x32_bf16 v[88:91], a[240:243], a[152:155], v[88:91]
    buffer_load_dwordx4 v230, s[28:31], s51 offen offset:1024 lds
    v_mfma_f32_16x16x32_bf16 v[84:87], a[240:243], a[144:147], 0
    v_mfma_f32_16x16x32_bf16 v[84:87], a[244:247], a[148:151], v[84:87]
    ds_read_b64_tr_b16 a[208:209], v152 offset:5120
    v_mfma_f32_16x16x32_bf16 v[80:83], a[244:247], a[140:143], 0
    buffer_load_dwordx4 v231, s[28:31], s51 offen offset:2048 lds
    v_mfma_f32_16x16x32_bf16 v[80:83], a[240:243], a[136:139], v[80:83]
    ds_read_b64_tr_b16 a[210:211], v152 offset:5376
    v_mfma_f32_16x16x32_bf16 v[96:99], a[248:251], a[136:139], 0
    ds_read_b64_tr_b16 a[212:213], v152 offset:27648
    v_mfma_f32_16x16x32_bf16 v[96:99], a[252:255], a[140:143], v[96:99]
    ds_read_b64_tr_b16 a[214:215], v152 offset:27904
    v_mfma_f32_16x16x32_bf16 v[100:103], a[252:255], a[148:151], 0
    buffer_load_dwordx4 v232, s[28:31], s51 offen offset:3072 lds
    v_mfma_f32_16x16x32_bf16 v[100:103], a[248:251], a[144:147], v[100:103]
    v_mfma_f32_16x16x32_bf16 v[104:107], a[248:251], a[152:155], 0
    ds_read_b64_tr_b16 a[216:217], v151 offset:7168
    v_mfma_f32_16x16x32_bf16 v[104:107], a[252:255], a[156:159], v[104:107]
    ds_read_b64_tr_b16 a[218:219], v151 offset:7424
    v_mfma_f32_16x16x32_bf16 v[108:111], a[252:255], a[164:167], 0
    ds_read_b64_tr_b16 a[220:221], v151 offset:29696
    v_mfma_f32_16x16x32_bf16 v[108:111], a[248:251], a[160:163], v[108:111]
    ds_read_b64_tr_b16 a[222:223], v151 offset:29952
    s_add_u32 m0, s96, 4096
    s_waitcnt lgkmcnt(8)
    v_mfma_f32_16x16x32_bf16 v[0:3], a[200:203], a[168:171], v[0:3]
    ds_read_b64_tr_b16 a[224:225], v152 offset:7168
    v_mfma_f32_16x16x32_bf16 v[0:3], a[204:207], a[172:175], v[0:3]
    ds_read_b64_tr_b16 a[226:227], v152 offset:7424
    v_mfma_f32_16x16x32_bf16 v[4:7], a[204:207], a[180:183], v[4:7]
    ds_read_b64_tr_b16 a[228:229], v152 offset:29696
    v_mfma_f32_16x16x32_bf16 v[4:7], a[200:203], a[176:179], v[4:7]
    buffer_load_dwordx4 v233, s[32:35], s52 offen offset:0 lds
    v_mfma_f32_16x16x32_bf16 v[8:11], a[200:203], a[184:187], v[8:11]
    ds_read_b64_tr_b16 a[230:231], v152 offset:29952
    v_mfma_f32_16x16x32_bf16 v[8:11], a[204:207], a[188:191], v[8:11]
    ds_read_b64_tr_b16 a[232:233], v151 offset:9216
    v_mfma_f32_16x16x32_bf16 v[12:15], a[204:207], a[196:199], v[12:15]
    ds_read_b64_tr_b16 a[234:235], v151 offset:9472
    ds_read_b64_tr_b16 a[236:237], v151 offset:31744
    v_mfma_f32_16x16x32_bf16 v[12:15], a[200:203], a[192:195], v[12:15]
    ds_read_b64_tr_b16 a[238:239], v151 offset:32000
    s_waitcnt lgkmcnt(12)
    v_mfma_f32_16x16x32_bf16 v[28:31], a[208:211], a[192:195], v[28:31]
    buffer_load_dwordx4 v234, s[32:35], s52 offen offset:1024 lds
    v_mfma_f32_16x16x32_bf16 v[28:31], a[212:215], a[196:199], v[28:31]
    ds_read_b64_tr_b16 a[240:241], v152 offset:9216
    v_mfma_f32_16x16x32_bf16 v[24:27], a[212:215], a[188:191], v[24:27]
    ds_read_b64_tr_b16 a[242:243], v152 offset:9472
    v_mfma_f32_16x16x32_bf16 v[24:27], a[208:211], a[184:187], v[24:27]
    ds_read_b64_tr_b16 a[244:245], v152 offset:31744
    v_mfma_f32_16x16x32_bf16 v[20:23], a[208:211], a[176:179], v[20:23]
    ds_read_b64_tr_b16 a[246:247], v152 offset:32000
    v_mfma_f32_16x16x32_bf16 v[20:23], a[212:215], a[180:183], v[20:23]
    ds_read_b64_tr_b16 a[248:249], v153 offset:4096
    v_mfma_f32_16x16x32_bf16 v[16:19], a[212:215], a[172:175], v[16:19]
    buffer_load_dwordx4 v235, s[32:35], s52 offen offset:2048 lds
    v_mfma_f32_16x16x32_bf16 v[16:19], a[208:211], a[168:171], v[16:19]
    ds_read_b64_tr_b16 a[250:251], v153 offset:4352
    s_waitcnt lgkmcnt(14)
    v_mfma_f32_16x16x32_bf16 v[32:35], a[216:219], a[168:171], v[32:35]
    ds_read_b64_tr_b16 a[252:253], v153 offset:26624
    v_mfma_f32_16x16x32_bf16 v[32:35], a[220:223], a[172:175], v[32:35]
    ds_read_b64_tr_b16 a[254:255], v153 offset:26880
    v_mfma_f32_16x16x32_bf16 v[36:39], a[220:223], a[180:183], v[36:39]
    buffer_load_dwordx4 v236, s[32:35], s52 offen offset:3072 lds
    v_mfma_f32_16x16x32_bf16 v[36:39], a[216:219], a[176:179], v[36:39]
    s_add_u32 m0, s96, 8192
    s_nop 0
    buffer_load_dwordx4 v237, s[32:35], s52 offen offset:0 lds
    v_mfma_f32_16x16x32_bf16 v[40:43], a[216:219], a[184:187], v[40:43]
    buffer_load_dwordx4 v238, s[32:35], s52 offen offset:1024 lds
    v_mfma_f32_16x16x32_bf16 v[40:43], a[220:223], a[188:191], v[40:43]
    buffer_load_dwordx4 v239, s[32:35], s52 offen offset:2048 lds
    v_mfma_f32_16x16x32_bf16 v[44:47], a[220:223], a[196:199], v[44:47]
    v_mfma_f32_16x16x32_bf16 v[44:47], a[216:219], a[192:195], v[44:47]
    s_addk_i32 s51, 128
    s_add_u32 s52, s52, s50
    s_waitcnt vmcnt(11) lgkmcnt(0)
    s_barrier
    v_mfma_f32_16x16x32_bf16 v[60:63], a[224:227], a[192:195], v[60:63]
    ds_read_b64_tr_b16 a[200:201], v154 offset:5120
    v_mfma_f32_16x16x32_bf16 v[60:63], a[228:231], a[196:199], v[60:63]
    s_add_u32 m0, s96, 45056
    v_mfma_f32_16x16x32_bf16 v[56:59], a[228:231], a[188:191], v[56:59]
    ds_read_b64_tr_b16 a[202:203], v154 offset:5376
    v_mfma_f32_16x16x32_bf16 v[56:59], a[224:227], a[184:187], v[56:59]
    ds_read_b64_tr_b16 a[204:205], v154 offset:27648
    v_mfma_f32_16x16x32_bf16 v[52:55], a[224:227], a[176:179], v[52:55]
    buffer_load_dwordx4 v229, s[28:31], s51 offen offset:0 lds
    v_mfma_f32_16x16x32_bf16 v[52:55], a[228:231], a[180:183], v[52:55]
    ds_read_b64_tr_b16 a[206:207], v154 offset:27904
    v_mfma_f32_16x16x32_bf16 v[48:51], a[228:231], a[172:175], v[48:51]
    ds_read_b128 a[136:139], v146 offset:0
    v_mfma_f32_16x16x32_bf16 v[48:51], a[224:227], a[168:171], v[48:51]
    buffer_load_dwordx4 v230, s[28:31], s51 offen offset:1024 lds
    v_mfma_f32_16x16x32_bf16 v[64:67], a[232:235], a[168:171], v[64:67]
    v_mfma_f32_16x16x32_bf16 v[64:67], a[236:239], a[172:175], v[64:67]
    ds_read_b128 a[140:143], v147 offset:0
    v_mfma_f32_16x16x32_bf16 v[68:71], a[236:239], a[180:183], v[68:71]
    ds_read_b128 a[144:147], v146 offset:2048
    v_mfma_f32_16x16x32_bf16 v[68:71], a[232:235], a[176:179], v[68:71]
    buffer_load_dwordx4 v231, s[28:31], s51 offen offset:2048 lds
    v_mfma_f32_16x16x32_bf16 v[72:75], a[232:235], a[184:187], v[72:75]
    v_mfma_f32_16x16x32_bf16 v[72:75], a[236:239], a[188:191], v[72:75]
    ds_read_b128 a[148:151], v147 offset:2048
    v_mfma_f32_16x16x32_bf16 v[76:79], a[236:239], a[196:199], v[76:79]
    ds_read_b128 a[152:155], v146 offset:11264
    v_mfma_f32_16x16x32_bf16 v[76:79], a[232:235], a[192:195], v[76:79]
    ds_read_b128 a[156:159], v147 offset:11264
    v_mfma_f32_16x16x32_bf16 v[92:95], a[240:243], a[192:195], v[92:95]
    ds_read_b128 a[160:163], v146 offset:13312
    v_mfma_f32_16x16x32_bf16 v[92:95], a[244:247], a[196:199], v[92:95]
    buffer_load_dwordx4 v232, s[28:31], s51 offen offset:3072 lds
    v_mfma_f32_16x16x32_bf16 v[88:91], a[244:247], a[188:191], v[88:91]
    v_mfma_f32_16x16x32_bf16 v[88:91], a[240:243], a[184:187], v[88:91]
    ds_read_b128 a[164:167], v147 offset:13312
    v_mfma_f32_16x16x32_bf16 v[84:87], a[240:243], a[176:179], v[84:87]
    ds_read_b64_tr_b16 a[208:209], v155 offset:5120
    v_mfma_f32_16x16x32_bf16 v[84:87], a[244:247], a[180:183], v[84:87]
    ds_read_b64_tr_b16 a[210:211], v155 offset:5376
    s_add_u32 m0, s96, 49152
    v_mfma_f32_16x16x32_bf16 v[80:83], a[244:247], a[172:175], v[80:83]
    ds_read_b64_tr_b16 a[212:213], v155 offset:27648
    v_mfma_f32_16x16x32_bf16 v[80:83], a[240:243], a[168:171], v[80:83]
    buffer_load_dwordx4 v233, s[32:35], s52 offen offset:0 lds
    v_mfma_f32_16x16x32_bf16 v[96:99], a[248:251], a[168:171], v[96:99]
    v_mfma_f32_16x16x32_bf16 v[96:99], a[252:255], a[172:175], v[96:99]
    ds_read_b64_tr_b16 a[214:215], v155 offset:27904
    v_mfma_f32_16x16x32_bf16 v[100:103], a[252:255], a[180:183], v[100:103]
    ds_read_b64_tr_b16 a[216:217], v154 offset:7168
    v_mfma_f32_16x16x32_bf16 v[100:103], a[248:251], a[176:179], v[100:103]
    buffer_load_dwordx4 v234, s[32:35], s52 offen offset:1024 lds
    v_mfma_f32_16x16x32_bf16 v[104:107], a[248:251], a[184:187], v[104:107]
    v_mfma_f32_16x16x32_bf16 v[104:107], a[252:255], a[188:191], v[104:107]
    ds_read_b64_tr_b16 a[218:219], v154 offset:7424
    v_mfma_f32_16x16x32_bf16 v[108:111], a[252:255], a[196:199], v[108:111]
    ds_read_b64_tr_b16 a[220:221], v154 offset:29696
    v_mfma_f32_16x16x32_bf16 v[108:111], a[248:251], a[192:195], v[108:111]
    ds_read_b64_tr_b16 a[222:223], v154 offset:29952
    s_waitcnt lgkmcnt(8)
    v_mfma_f32_16x16x32_bf16 v[0:3], a[200:203], a[136:139], v[0:3]
    ds_read_b64_tr_b16 a[224:225], v155 offset:7168
    v_mfma_f32_16x16x32_bf16 v[0:3], a[204:207], a[140:143], v[0:3]
    ds_read_b64_tr_b16 a[226:227], v155 offset:7424
    v_mfma_f32_16x16x32_bf16 v[4:7], a[204:207], a[148:151], v[4:7]
    ds_read_b64_tr_b16 a[228:229], v155 offset:29696
    v_mfma_f32_16x16x32_bf16 v[4:7], a[200:203], a[144:147], v[4:7]
    ds_read_b64_tr_b16 a[230:231], v155 offset:29952
    v_mfma_f32_16x16x32_bf16 v[8:11], a[200:203], a[152:155], v[8:11]
    buffer_load_dwordx4 v235, s[32:35], s52 offen offset:2048 lds
    v_mfma_f32_16x16x32_bf16 v[8:11], a[204:207], a[156:159], v[8:11]
    ds_read_b64_tr_b16 a[232:233], v154 offset:9216
    v_mfma_f32_16x16x32_bf16 v[12:15], a[204:207], a[164:167], v[12:15]
    ds_read_b64_tr_b16 a[234:235], v154 offset:9472
    v_mfma_f32_16x16x32_bf16 v[12:15], a[200:203], a[160:163], v[12:15]
    ds_read_b64_tr_b16 a[236:237], v154 offset:31744
    s_waitcnt lgkmcnt(11)
    v_mfma_f32_16x16x32_bf16 v[28:31], a[208:211], a[160:163], v[28:31]
    ds_read_b64_tr_b16 a[238:239], v154 offset:32000
    v_mfma_f32_16x16x32_bf16 v[28:31], a[212:215], a[164:167], v[28:31]
    ds_read_b64_tr_b16 a[240:241], v155 offset:9216
    v_mfma_f32_16x16x32_bf16 v[24:27], a[212:215], a[156:159], v[24:27]
    ds_read_b64_tr_b16 a[242:243], v155 offset:9472
    v_mfma_f32_16x16x32_bf16 v[24:27], a[208:211], a[152:155], v[24:27]
    ds_read_b64_tr_b16 a[244:245], v155 offset:31744
    v_mfma_f32_16x16x32_bf16 v[20:23], a[208:211], a[144:147], v[20:23]
    ds_read_b64_tr_b16 a[246:247], v155 offset:32000
    v_mfma_f32_16x16x32_bf16 v[20:23], a[212:215], a[148:151], v[20:23]
    buffer_load_dwordx4 v236, s[32:35], s52 offen offset:3072 lds
    v_mfma_f32_16x16x32_bf16 v[16:19], a[212:215], a[140:143], v[16:19]
    ds_read_b64_tr_b16 a[248:249], v156 offset:4096
    v_mfma_f32_16x16x32_bf16 v[16:19], a[208:211], a[136:139], v[16:19]
    ds_read_b64_tr_b16 a[250:251], v156 offset:4352
    s_waitcnt lgkmcnt(14)
    v_mfma_f32_16x16x32_bf16 v[32:35], a[216:219], a[136:139], v[32:35]
    ds_read_b64_tr_b16 a[252:253], v156 offset:26624
    v_mfma_f32_16x16x32_bf16 v[32:35], a[220:223], a[140:143], v[32:35]
    ds_read_b64_tr_b16 a[254:255], v156 offset:26880
    s_add_u32 m0, s96, 53248
    v_mfma_f32_16x16x32_bf16 v[36:39], a[220:223], a[148:151], v[36:39]
    buffer_load_dwordx4 v237, s[32:35], s52 offen offset:0 lds
    v_mfma_f32_16x16x32_bf16 v[36:39], a[216:219], a[144:147], v[36:39]
    buffer_load_dwordx4 v238, s[32:35], s52 offen offset:1024 lds
    v_mfma_f32_16x16x32_bf16 v[40:43], a[216:219], a[152:155], v[40:43]
    buffer_load_dwordx4 v239, s[32:35], s52 offen offset:2048 lds
    v_mfma_f32_16x16x32_bf16 v[40:43], a[220:223], a[156:159], v[40:43]
    v_mfma_f32_16x16x32_bf16 v[44:47], a[220:223], a[164:167], v[44:47]
    v_mfma_f32_16x16x32_bf16 v[44:47], a[216:219], a[160:163], v[44:47]
    s_addk_i32 s51, 128
    s_add_u32 s52, s52, s50
    s_waitcnt vmcnt(11) lgkmcnt(0)
    s_barrier
    v_mfma_f32_16x16x32_bf16 v[60:63], a[224:227], a[160:163], v[60:63]
    ds_read_b64_tr_b16 a[200:201], v148 offset:5120
    v_mfma_f32_16x16x32_bf16 v[60:63], a[228:231], a[164:167], v[60:63]
    s_add_u32 m0, s96, 90112
    v_mfma_f32_16x16x32_bf16 v[56:59], a[228:231], a[156:159], v[56:59]
    ds_read_b64_tr_b16 a[202:203], v148 offset:5376
    v_mfma_f32_16x16x32_bf16 v[56:59], a[224:227], a[152:155], v[56:59]
    ds_read_b64_tr_b16 a[204:205], v148 offset:27648
    v_mfma_f32_16x16x32_bf16 v[52:55], a[224:227], a[144:147], v[52:55]
    buffer_load_dwordx4 v229, s[28:31], s51 offen offset:0 lds
    v_mfma_f32_16x16x32_bf16 v[52:55], a[228:231], a[148:151], v[52:55]
    ds_read_b64_tr_b16 a[206:207], v148 offset:27904
    v_mfma_f32_16x16x32_bf16 v[48:51], a[228:231], a[140:143], v[48:51]
    ds_read_b128 a[168:171], v144 offset:0
    v_mfma_f32_16x16x32_bf16 v[48:51], a[224:227], a[136:139], v[48:51]
    buffer_load_dwordx4 v230, s[28:31], s51 offen offset:1024 lds
    v_mfma_f32_16x16x32_bf16 v[64:67], a[232:235], a[136:139], v[64:67]
    v_mfma_f32_16x16x32_bf16 v[64:67], a[236:239], a[140:143], v[64:67]
    ds_read_b128 a[172:175], v145 offset:0
    v_mfma_f32_16x16x32_bf16 v[68:71], a[236:239], a[148:151], v[68:71]
    ds_read_b128 a[176:179], v144 offset:2048
    v_mfma_f32_16x16x32_bf16 v[68:71], a[232:235], a[144:147], v[68:71]
    buffer_load_dwordx4 v231, s[28:31], s51 offen offset:2048 lds
    v_mfma_f32_16x16x32_bf16 v[72:75], a[232:235], a[152:155], v[72:75]
    v_mfma_f32_16x16x32_bf16 v[72:75], a[236:239], a[156:159], v[72:75]
    ds_read_b128 a[180:183], v145 offset:2048
    v_mfma_f32_16x16x32_bf16 v[76:79], a[236:239], a[164:167], v[76:79]
    ds_read_b128 a[184:187], v144 offset:11264
    v_mfma_f32_16x16x32_bf16 v[76:79], a[232:235], a[160:163], v[76:79]
    ds_read_b128 a[188:191], v145 offset:11264
    v_mfma_f32_16x16x32_bf16 v[92:95], a[240:243], a[160:163], v[92:95]
    ds_read_b128 a[192:195], v144 offset:13312
    v_mfma_f32_16x16x32_bf16 v[92:95], a[244:247], a[164:167], v[92:95]
    buffer_load_dwordx4 v232, s[28:31], s51 offen offset:3072 lds
    v_mfma_f32_16x16x32_bf16 v[88:91], a[244:247], a[156:159], v[88:91]
    v_mfma_f32_16x16x32_bf16 v[88:91], a[240:243], a[152:155], v[88:91]
    ds_read_b128 a[196:199], v145 offset:13312
    v_mfma_f32_16x16x32_bf16 v[84:87], a[240:243], a[144:147], v[84:87]
    ds_read_b64_tr_b16 a[208:209], v149 offset:5120
    v_mfma_f32_16x16x32_bf16 v[84:87], a[244:247], a[148:151], v[84:87]
    ds_read_b64_tr_b16 a[210:211], v149 offset:5376
    s_add_u32 m0, s96, 94208
    v_mfma_f32_16x16x32_bf16 v[80:83], a[244:247], a[140:143], v[80:83]
    ds_read_b64_tr_b16 a[212:213], v149 offset:27648
    v_mfma_f32_16x16x32_bf16 v[80:83], a[240:243], a[136:139], v[80:83]
    buffer_load_dwordx4 v233, s[32:35], s52 offen offset:0 lds
    v_mfma_f32_16x16x32_bf16 v[96:99], a[248:251], a[136:139], v[96:99]
    v_mfma_f32_16x16x32_bf16 v[96:99], a[252:255], a[140:143], v[96:99]
    ds_read_b64_tr_b16 a[214:215], v149 offset:27904
    v_mfma_f32_16x16x32_bf16 v[100:103], a[252:255], a[148:151], v[100:103]
    ds_read_b64_tr_b16 a[216:217], v148 offset:7168
    v_mfma_f32_16x16x32_bf16 v[100:103], a[248:251], a[144:147], v[100:103]
    buffer_load_dwordx4 v234, s[32:35], s52 offen offset:1024 lds
    v_mfma_f32_16x16x32_bf16 v[104:107], a[248:251], a[152:155], v[104:107]
    v_mfma_f32_16x16x32_bf16 v[104:107], a[252:255], a[156:159], v[104:107]
    ds_read_b64_tr_b16 a[218:219], v148 offset:7424
    v_mfma_f32_16x16x32_bf16 v[108:111], a[252:255], a[164:167], v[108:111]
    ds_read_b64_tr_b16 a[220:221], v148 offset:29696
    v_mfma_f32_16x16x32_bf16 v[108:111], a[248:251], a[160:163], v[108:111]
    ds_read_b64_tr_b16 a[222:223], v148 offset:29952
    s_waitcnt lgkmcnt(8)
    v_mfma_f32_16x16x32_bf16 v[0:3], a[200:203], a[168:171], v[0:3]
    ds_read_b64_tr_b16 a[224:225], v149 offset:7168
    v_mfma_f32_16x16x32_bf16 v[0:3], a[204:207], a[172:175], v[0:3]
    ds_read_b64_tr_b16 a[226:227], v149 offset:7424
    v_mfma_f32_16x16x32_bf16 v[4:7], a[204:207], a[180:183], v[4:7]
    ds_read_b64_tr_b16 a[228:229], v149 offset:29696
    v_mfma_f32_16x16x32_bf16 v[4:7], a[200:203], a[176:179], v[4:7]
    ds_read_b64_tr_b16 a[230:231], v149 offset:29952
    v_mfma_f32_16x16x32_bf16 v[8:11], a[200:203], a[184:187], v[8:11]
    buffer_load_dwordx4 v235, s[32:35], s52 offen offset:2048 lds
    v_mfma_f32_16x16x32_bf16 v[8:11], a[204:207], a[188:191], v[8:11]
    ds_read_b64_tr_b16 a[232:233], v148 offset:9216
    v_mfma_f32_16x16x32_bf16 v[12:15], a[204:207], a[196:199], v[12:15]
    ds_read_b64_tr_b16 a[234:235], v148 offset:9472
    v_mfma_f32_16x16x32_bf16 v[12:15], a[200:203], a[192:195], v[12:15]
    ds_read_b64_tr_b16 a[236:237], v148 offset:31744
    s_waitcnt lgkmcnt(11)
    v_mfma_f32_16x16x32_bf16 v[28:31], a[208:211], a[192:195], v[28:31]
    ds_read_b64_tr_b16 a[238:239], v148 offset:32000
    v_mfma_f32_16x16x32_bf16 v[28:31], a[212:215], a[196:199], v[28:31]
    ds_read_b64_tr_b16 a[240:241], v149 offset:9216
    v_mfma_f32_16x16x32_bf16 v[24:27], a[212:215], a[188:191], v[24:27]
    ds_read_b64_tr_b16 a[242:243], v149 offset:9472
    v_mfma_f32_16x16x32_bf16 v[24:27], a[208:211], a[184:187], v[24:27]
    ds_read_b64_tr_b16 a[244:245], v149 offset:31744
    v_mfma_f32_16x16x32_bf16 v[20:23], a[208:211], a[176:179], v[20:23]
    ds_read_b64_tr_b16 a[246:247], v149 offset:32000
    v_mfma_f32_16x16x32_bf16 v[20:23], a[212:215], a[180:183], v[20:23]
    buffer_load_dwordx4 v236, s[32:35], s52 offen offset:3072 lds
    v_mfma_f32_16x16x32_bf16 v[16:19], a[212:215], a[172:175], v[16:19]
    ds_read_b64_tr_b16 a[248:249], v150 offset:4096
    v_mfma_f32_16x16x32_bf16 v[16:19], a[208:211], a[168:171], v[16:19]
    ds_read_b64_tr_b16 a[250:251], v150 offset:4352
    s_waitcnt lgkmcnt(14)
    v_mfma_f32_16x16x32_bf16 v[32:35], a[216:219], a[168:171], v[32:35]
    ds_read_b64_tr_b16 a[252:253], v150 offset:26624
    v_mfma_f32_16x16x32_bf16 v[32:35], a[220:223], a[172:175], v[32:35]
    ds_read_b64_tr_b16 a[254:255], v150 offset:26880
    s_add_u32 m0, s96, 98304
    v_mfma_f32_16x16x32_bf16 v[36:39], a[220:223], a[180:183], v[36:39]
    buffer_load_dwordx4 v237, s[32:35], s52 offen offset:0 lds
    v_mfma_f32_16x16x32_bf16 v[36:39], a[216:219], a[176:179], v[36:39]
    buffer_load_dwordx4 v238, s[32:35], s52 offen offset:1024 lds
    v_mfma_f32_16x16x32_bf16 v[40:43], a[216:219], a[184:187], v[40:43]
    buffer_load_dwordx4 v239, s[32:35], s52 offen offset:2048 lds
    v_mfma_f32_16x16x32_bf16 v[40:43], a[220:223], a[188:191], v[40:43]
    v_mfma_f32_16x16x32_bf16 v[44:47], a[220:223], a[196:199], v[44:47]
    v_mfma_f32_16x16x32_bf16 v[44:47], a[216:219], a[192:195], v[44:47]
    s_addk_i32 s51, 128
    s_add_u32 s52, s52, s50
    s_waitcnt vmcnt(11) lgkmcnt(0)
    s_barrier
    v_mfma_f32_16x16x32_bf16 v[60:63], a[224:227], a[192:195], v[60:63]
    ds_read_b64_tr_b16 a[200:201], v151 offset:5120
    v_mfma_f32_16x16x32_bf16 v[60:63], a[228:231], a[196:199], v[60:63]
    s_add_u32 m0, s96, 0
    v_mfma_f32_16x16x32_bf16 v[56:59], a[228:231], a[188:191], v[56:59]
    ds_read_b64_tr_b16 a[202:203], v151 offset:5376
    v_mfma_f32_16x16x32_bf16 v[56:59], a[224:227], a[184:187], v[56:59]
    ds_read_b64_tr_b16 a[204:205], v151 offset:27648
    v_mfma_f32_16x16x32_bf16 v[52:55], a[224:227], a[176:179], v[52:55]
    buffer_load_dwordx4 v229, s[28:31], s51 offen offset:0 lds
    v_mfma_f32_16x16x32_bf16 v[52:55], a[228:231], a[180:183], v[52:55]
    ds_read_b64_tr_b16 a[206:207], v151 offset:27904
    v_mfma_f32_16x16x32_bf16 v[48:51], a[228:231], a[172:175], v[48:51]
    ds_read_b128 a[136:139], v144 offset:45056
    v_mfma_f32_16x16x32_bf16 v[48:51], a[224:227], a[168:171], v[48:51]
    buffer_load_dwordx4 v230, s[28:31], s51 offen offset:1024 lds
    v_mfma_f32_16x16x32_bf16 v[64:67], a[232:235], a[168:171], v[64:67]
    v_mfma_f32_16x16x32_bf16 v[64:67], a[236:239], a[172:175], v[64:67]
    ds_read_b128 a[140:143], v145 offset:45056
    v_mfma_f32_16x16x32_bf16 v[68:71], a[236:239], a[180:183], v[68:71]
    ds_read_b128 a[144:147], v144 offset:47104
    v_mfma_f32_16x16x32_bf16 v[68:71], a[232:235], a[176:179], v[68:71]
    buffer_load_dwordx4 v231, s[28:31], s51 offen offset:2048 lds
    v_mfma_f32_16x16x32_bf16 v[72:75], a[232:235], a[184:187], v[72:75]
    v_mfma_f32_16x16x32_bf16 v[72:75], a[236:239], a[188:191], v[72:75]
    ds_read_b128 a[148:151], v145 offset:47104
    v_mfma_f32_16x16x32_bf16 v[76:79], a[236:239], a[196:199], v[76:79]
    ds_read_b128 a[152:155], v144 offset:56320
    v_mfma_f32_16x16x32_bf16 v[76:79], a[232:235], a[192:195], v[76:79]
    ds_read_b128 a[156:159], v145 offset:56320
    v_mfma_f32_16x16x32_bf16 v[92:95], a[240:243], a[192:195], v[92:95]
    ds_read_b128 a[160:163], v144 offset:58368
    v_mfma_f32_16x16x32_bf16 v[92:95], a[244:247], a[196:199], v[92:95]
    buffer_load_dwordx4 v232, s[28:31], s51 offen offset:3072 lds
    v_mfma_f32_16x16x32_bf16 v[88:91], a[244:247], a[188:191], v[88:91]
    v_mfma_f32_16x16x32_bf16 v[88:91], a[240:243], a[184:187], v[88:91]
    ds_read_b128 a[164:167], v145 offset:58368
    v_mfma_f32_16x16x32_bf16 v[84:87], a[240:243], a[176:179], v[84:87]
    ds_read_b64_tr_b16 a[208:209], v152 offset:5120
    v_mfma_f32_16x16x32_bf16 v[84:87], a[244:247], a[180:183], v[84:87]
    ds_read_b64_tr_b16 a[210:211], v152 offset:5376
    s_add_u32 m0, s96, 4096
    v_mfma_f32_16x16x32_bf16 v[80:83], a[244:247], a[172:175], v[80:83]
    ds_read_b64_tr_b16 a[212:213], v152 offset:27648
    v_mfma_f32_16x16x32_bf16 v[80:83], a[240:243], a[168:171], v[80:83]
    buffer_load_dwordx4 v233, s[32:35], s52 offen offset:0 lds
    v_mfma_f32_16x16x32_bf16 v[96:99], a[248:251], a[168:171], v[96:99]
    v_mfma_f32_16x16x32_bf16 v[96:99], a[252:255], a[172:175], v[96:99]
    ds_read_b64_tr_b16 a[214:215], v152 offset:27904
    v_mfma_f32_16x16x32_bf16 v[100:103], a[252:255], a[180:183], v[100:103]
    ds_read_b64_tr_b16 a[216:217], v151 offset:7168
    v_mfma_f32_16x16x32_bf16 v[100:103], a[248:251], a[176:179], v[100:103]
    buffer_load_dwordx4 v234, s[32:35], s52 offen offset:1024 lds
    v_mfma_f32_16x16x32_bf16 v[104:107], a[248:251], a[184:187], v[104:107]
    v_mfma_f32_16x16x32_bf16 v[104:107], a[252:255], a[188:191], v[104:107]
    ds_read_b64_tr_b16 a[218:219], v151 offset:7424
    v_mfma_f32_16x16x32_bf16 v[108:111], a[252:255], a[196:199], v[108:111]
    ds_read_b64_tr_b16 a[220:221], v151 offset:29696
    v_mfma_f32_16x16x32_bf16 v[108:111], a[248:251], a[192:195], v[108:111]
    ds_read_b64_tr_b16 a[222:223], v151 offset:29952
    s_waitcnt lgkmcnt(8)
    v_mfma_f32_16x16x32_bf16 v[0:3], a[200:203], a[136:139], v[0:3]
    ds_read_b64_tr_b16 a[224:225], v152 offset:7168
    v_mfma_f32_16x16x32_bf16 v[0:3], a[204:207], a[140:143], v[0:3]
    ds_read_b64_tr_b16 a[226:227], v152 offset:7424
    v_mfma_f32_16x16x32_bf16 v[4:7], a[204:207], a[148:151], v[4:7]
    ds_read_b64_tr_b16 a[228:229], v152 offset:29696
    v_mfma_f32_16x16x32_bf16 v[4:7], a[200:203], a[144:147], v[4:7]
    ds_read_b64_tr_b16 a[230:231], v152 offset:29952
    v_mfma_f32_16x16x32_bf16 v[8:11], a[200:203], a[152:155], v[8:11]
    buffer_load_dwordx4 v235, s[32:35], s52 offen offset:2048 lds
    v_mfma_f32_16x16x32_bf16 v[8:11], a[204:207], a[156:159], v[8:11]
    ds_read_b64_tr_b16 a[232:233], v151 offset:9216
    v_mfma_f32_16x16x32_bf16 v[12:15], a[204:207], a[164:167], v[12:15]
    ds_read_b64_tr_b16 a[234:235], v151 offset:9472
    v_mfma_f32_16x16x32_bf16 v[12:15], a[200:203], a[160:163], v[12:15]
    ds_read_b64_tr_b16 a[236:237], v151 offset:31744
    s_waitcnt lgkmcnt(11)
    v_mfma_f32_16x16x32_bf16 v[28:31], a[208:211], a[160:163], v[28:31]
    ds_read_b64_tr_b16 a[238:239], v151 offset:32000
    v_mfma_f32_16x16x32_bf16 v[28:31], a[212:215], a[164:167], v[28:31]
    ds_read_b64_tr_b16 a[240:241], v152 offset:9216
    v_mfma_f32_16x16x32_bf16 v[24:27], a[212:215], a[156:159], v[24:27]
    ds_read_b64_tr_b16 a[242:243], v152 offset:9472
    v_mfma_f32_16x16x32_bf16 v[24:27], a[208:211], a[152:155], v[24:27]
    ds_read_b64_tr_b16 a[244:245], v152 offset:31744
    v_mfma_f32_16x16x32_bf16 v[20:23], a[208:211], a[144:147], v[20:23]
    ds_read_b64_tr_b16 a[246:247], v152 offset:32000
    v_mfma_f32_16x16x32_bf16 v[20:23], a[212:215], a[148:151], v[20:23]
    buffer_load_dwordx4 v236, s[32:35], s52 offen offset:3072 lds
    v_mfma_f32_16x16x32_bf16 v[16:19], a[212:215], a[140:143], v[16:19]
    ds_read_b64_tr_b16 a[248:249], v153 offset:4096
    v_mfma_f32_16x16x32_bf16 v[16:19], a[208:211], a[136:139], v[16:19]
    ds_read_b64_tr_b16 a[250:251], v153 offset:4352
    s_waitcnt lgkmcnt(14)
    v_mfma_f32_16x16x32_bf16 v[32:35], a[216:219], a[136:139], v[32:35]
    ds_read_b64_tr_b16 a[252:253], v153 offset:26624
    v_mfma_f32_16x16x32_bf16 v[32:35], a[220:223], a[140:143], v[32:35]
    ds_read_b64_tr_b16 a[254:255], v153 offset:26880
    s_add_u32 m0, s96, 8192
    v_mfma_f32_16x16x32_bf16 v[36:39], a[220:223], a[148:151], v[36:39]
    buffer_load_dwordx4 v237, s[32:35], s52 offen offset:0 lds
    v_mfma_f32_16x16x32_bf16 v[36:39], a[216:219], a[144:147], v[36:39]
    buffer_load_dwordx4 v238, s[32:35], s52 offen offset:1024 lds
    v_mfma_f32_16x16x32_bf16 v[40:43], a[216:219], a[152:155], v[40:43]
    buffer_load_dwordx4 v239, s[32:35], s52 offen offset:2048 lds
    v_mfma_f32_16x16x32_bf16 v[40:43], a[220:223], a[156:159], v[40:43]
    v_mfma_f32_16x16x32_bf16 v[44:47], a[220:223], a[164:167], v[44:47]
    v_mfma_f32_16x16x32_bf16 v[44:47], a[216:219], a[160:163], v[44:47]
    s_addk_i32 s51, 128
    s_add_u32 s52, s52, s50
    s_waitcnt vmcnt(11) lgkmcnt(0)
    s_barrier
    v_mfma_f32_16x16x32_bf16 v[60:63], a[224:227], a[160:163], v[60:63]
    ds_read_b64_tr_b16 a[200:201], v154 offset:5120
    v_mfma_f32_16x16x32_bf16 v[60:63], a[228:231], a[164:167], v[60:63]
    s_add_u32 m0, s96, 45056
    v_mfma_f32_16x16x32_bf16 v[56:59], a[228:231], a[156:159], v[56:59]
    ds_read_b64_tr_b16 a[202:203], v154 offset:5376
    v_mfma_f32_16x16x32_bf16 v[56:59], a[224:227], a[152:155], v[56:59]
    ds_read_b64_tr_b16 a[204:205], v154 offset:27648
    v_mfma_f32_16x16x32_bf16 v[52:55], a[224:227], a[144:147], v[52:55]
    buffer_load_dwordx4 v229, s[28:31], s51 offen offset:0 lds
    v_mfma_f32_16x16x32_bf16 v[52:55], a[228:231], a[148:151], v[52:55]
    ds_read_b64_tr_b16 a[206:207], v154 offset:27904
    v_mfma_f32_16x16x32_bf16 v[48:51], a[228:231], a[140:143], v[48:51]
    ds_read_b128 a[168:171], v146 offset:0
    v_mfma_f32_16x16x32_bf16 v[48:51], a[224:227], a[136:139], v[48:51]
    buffer_load_dwordx4 v230, s[28:31], s51 offen offset:1024 lds
    v_mfma_f32_16x16x32_bf16 v[64:67], a[232:235], a[136:139], v[64:67]
    v_mfma_f32_16x16x32_bf16 v[64:67], a[236:239], a[140:143], v[64:67]
    ds_read_b128 a[172:175], v147 offset:0
    v_mfma_f32_16x16x32_bf16 v[68:71], a[236:239], a[148:151], v[68:71]
    buffer_load_dword v208, v242, s[44:47], 0 offen sc1
    v_mfma_f32_16x16x32_bf16 v[68:71], a[232:235], a[144:147], v[68:71]
    ds_read_b128 a[176:179], v146 offset:2048
    v_mfma_f32_16x16x32_bf16 v[72:75], a[232:235], a[152:155], v[72:75]
    ds_read_b128 a[180:183], v147 offset:2048
    v_mfma_f32_16x16x32_bf16 v[72:75], a[236:239], a[156:159], v[72:75]
    buffer_load_dwordx4 v231, s[28:31], s51 offen offset:2048 lds
    v_mfma_f32_16x16x32_bf16 v[76:79], a[236:239], a[164:167], v[76:79]
    v_mfma_f32_16x16x32_bf16 v[76:79], a[232:235], a[160:163], v[76:79]
    ds_read_b128 a[184:187], v146 offset:11264
    v_mfma_f32_16x16x32_bf16 v[92:95], a[240:243], a[160:163], v[92:95]
    ds_read_b128 a[188:191], v147 offset:11264
    v_mfma_f32_16x16x32_bf16 v[92:95], a[244:247], a[164:167], v[92:95]
    ds_read_b128 a[192:195], v146 offset:13312
    v_mfma_f32_16x16x32_bf16 v[88:91], a[244:247], a[156:159], v[88:91]
    ds_read_b128 a[196:199], v147 offset:13312
    v_mfma_f32_16x16x32_bf16 v[88:91], a[240:243], a[152:155], v[88:91]
    buffer_load_dwordx4 v232, s[28:31], s51 offen offset:3072 lds
    v_mfma_f32_16x16x32_bf16 v[84:87], a[240:243], a[144:147], v[84:87]
    ds_read_b64_tr_b16 a[208:209], v155 offset:5120
    v_mfma_f32_16x16x32_bf16 v[84:87], a[244:247], a[148:151], v[84:87]
    ds_read_b64_tr_b16 a[210:211], v155 offset:5376
    v_mfma_f32_16x16x32_bf16 v[80:83], a[244:247], a[140:143], v[80:83]
    s_add_u32 m0, s96, 49152
    v_mfma_f32_16x16x32_bf16 v[80:83], a[240:243], a[136:139], v[80:83]
    ds_read_b64_tr_b16 a[212:213], v155 offset:27648
    v_mfma_f32_16x16x32_bf16 v[96:99], a[248:251], a[136:139], v[96:99]
    buffer_load_dwordx4 v233, s[32:35], s52 offen offset:0 lds
    v_mfma_f32_16x16x32_bf16 v[96:99], a[252:255], a[140:143], v[96:99]
    ds_read_b64_tr_b16 a[214:215], v155 offset:27904
    v_mfma_f32_16x16x32_bf16 v[100:103], a[252:255], a[148:151], v[100:103]
    ds_read_b64_tr_b16 a[216:217], v154 offset:7168
    v_mfma_f32_16x16x32_bf16 v[100:103], a[248:251], a[144:147], v[100:103]
    ds_read_b64_tr_b16 a[218:219], v154 offset:7424
    v_mfma_f32_16x16x32_bf16 v[104:107], a[248:251], a[152:155], v[104:107]
    ds_read_b64_tr_b16 a[220:221], v154 offset:29696
    v_mfma_f32_16x16x32_bf16 v[104:107], a[252:255], a[156:159], v[104:107]
    buffer_load_dwordx4 v234, s[32:35], s52 offen offset:1024 lds
    v_mfma_f32_16x16x32_bf16 v[108:111], a[252:255], a[164:167], v[108:111]
    v_mfma_f32_16x16x32_bf16 v[108:111], a[248:251], a[160:163], v[108:111]
    ds_read_b64_tr_b16 a[222:223], v154 offset:29952
    s_waitcnt lgkmcnt(8)
    v_mfma_f32_16x16x32_bf16 v[0:3], a[200:203], a[168:171], v[0:3]
    ds_read_b64_tr_b16 a[224:225], v155 offset:7168
    v_mfma_f32_16x16x32_bf16 v[0:3], a[204:207], a[172:175], v[0:3]
    ds_read_b64_tr_b16 a[226:227], v155 offset:7424
    v_mfma_f32_16x16x32_bf16 v[4:7], a[204:207], a[180:183], v[4:7]
    ds_read_b64_tr_b16 a[228:229], v155 offset:29696
    v_mfma_f32_16x16x32_bf16 v[4:7], a[200:203], a[176:179], v[4:7]
    ds_read_b64_tr_b16 a[230:231], v155 offset:29952
    v_mfma_f32_16x16x32_bf16 v[8:11], a[200:203], a[184:187], v[8:11]
    buffer_load_dwordx4 v235, s[32:35], s52 offen offset:2048 lds
    v_mfma_f32_16x16x32_bf16 v[8:11], a[204:207], a[188:191], v[8:11]
    ds_read_b64_tr_b16 a[232:233], v154 offset:9216
    v_mfma_f32_16x16x32_bf16 v[12:15], a[204:207], a[196:199], v[12:15]
    ds_read_b64_tr_b16 a[234:235], v154 offset:9472
    v_mfma_f32_16x16x32_bf16 v[12:15], a[200:203], a[192:195], v[12:15]
    ds_read_b64_tr_b16 a[236:237], v154 offset:31744
    s_waitcnt lgkmcnt(11)
    v_mfma_f32_16x16x32_bf16 v[28:31], a[208:211], a[192:195], v[28:31]
    ds_read_b64_tr_b16 a[238:239], v154 offset:32000
    v_mfma_f32_16x16x32_bf16 v[28:31], a[212:215], a[196:199], v[28:31]
    ds_read_b64_tr_b16 a[240:241], v155 offset:9216
    v_mfma_f32_16x16x32_bf16 v[24:27], a[212:215], a[188:191], v[24:27]
    ds_read_b64_tr_b16 a[242:243], v155 offset:9472
    v_mfma_f32_16x16x32_bf16 v[24:27], a[208:211], a[184:187], v[24:27]
    ds_read_b64_tr_b16 a[244:245], v155 offset:31744
    v_mfma_f32_16x16x32_bf16 v[20:23], a[208:211], a[176:179], v[20:23]
    ds_read_b64_tr_b16 a[246:247], v155 offset:32000
    v_mfma_f32_16x16x32_bf16 v[20:23], a[212:215], a[180:183], v[20:23]
    buffer_load_dwordx4 v236, s[32:35], s52 offen offset:3072 lds
    v_mfma_f32_16x16x32_bf16 v[16:19], a[212:215], a[172:175], v[16:19]
    ds_read_b64_tr_b16 a[248:249], v156 offset:4096
    v_mfma_f32_16x16x32_bf16 v[16:19], a[208:211], a[168:171], v[16:19]
    ds_read_b64_tr_b16 a[250:251], v156 offset:4352
    s_waitcnt lgkmcnt(14)
    v_mfma_f32_16x16x32_bf16 v[32:35], a[216:219], a[168:171], v[32:35]
    ds_read_b64_tr_b16 a[252:253], v156 offset:26624
    v_mfma_f32_16x16x32_bf16 v[32:35], a[220:223], a[172:175], v[32:35]
    ds_read_b64_tr_b16 a[254:255], v156 offset:26880
    s_add_u32 m0, s96, 53248
    v_mfma_f32_16x16x32_bf16 v[36:39], a[220:223], a[180:183], v[36:39]
    buffer_load_dwordx4 v237, s[32:35], s52 offen offset:0 lds
    v_mfma_f32_16x16x32_bf16 v[36:39], a[216:219], a[176:179], v[36:39]
    buffer_load_dwordx4 v238, s[32:35], s52 offen offset:1024 lds
    v_mfma_f32_16x16x32_bf16 v[40:43], a[216:219], a[184:187], v[40:43]
    buffer_load_dwordx4 v239, s[32:35], s52 offen offset:2048 lds
    v_mfma_f32_16x16x32_bf16 v[40:43], a[220:223], a[188:191], v[40:43]
    v_mfma_f32_16x16x32_bf16 v[44:47], a[220:223], a[196:199], v[44:47]
    v_mfma_f32_16x16x32_bf16 v[44:47], a[216:219], a[192:195], v[44:47]
    s_waitcnt vmcnt(12) lgkmcnt(0)
    s_barrier
    v_mfma_f32_16x16x32_bf16 v[60:63], a[224:227], a[192:195], v[60:63]
    ds_read_b64_tr_b16 a[200:201], v148 offset:5120
    s_waitcnt vmcnt(9)
    v_cmp_le_u32 vcc, 64, v208
    v_mfma_f32_16x16x32_bf16 v[60:63], a[228:231], a[196:199], v[60:63]
    ds_read_b64_tr_b16 a[202:203], v148 offset:5376
    v_mfma_f32_16x16x32_bf16 v[56:59], a[228:231], a[188:191], v[56:59]
    s_cmp_eq_u64 vcc, -1
    s_cbranch_scc0 L_ffsf_spin
L_ffsf_ok:
    v_mfma_f32_16x16x32_bf16 v[56:59], a[224:227], a[184:187], v[56:59]
    ds_read_b64_tr_b16 a[204:205], v148 offset:27648
    s_add_u32 m0, s92, 135168
    v_mfma_f32_16x16x32_bf16 v[52:55], a[224:227], a[176:179], v[52:55]
    ds_read_b64_tr_b16 a[206:207], v148 offset:27904
    v_mfma_f32_16x16x32_bf16 v[52:55], a[228:231], a[180:183], v[52:55]
    ds_read_b128 a[136:139], v144 offset:0
    v_mfma_f32_16x16x32_bf16 v[48:51], a[228:231], a[172:175], v[48:51]
    s_sub_u32 s76, s18, 2048
    s_subb_u32 s77, s19, 0
    v_mfma_f32_16x16x32_bf16 v[48:51], a[224:227], a[168:171], v[48:51]
    ds_read_b128 a[140:143], v145 offset:0
    v_mfma_f32_16x16x32_bf16 v[64:67], a[232:235], a[168:171], v[64:67]
    buffer_load_dwordx4 v157, s[36:39], s90 offen offset:0 sc1 lds
    v_mfma_f32_16x16x32_bf16 v[64:67], a[236:239], a[172:175], v[64:67]
    ds_read_b128 a[144:147], v144 offset:2048
    v_mfma_f32_16x16x32_bf16 v[68:71], a[236:239], a[180:183], v[68:71]
    buffer_load_dwordx4 v157, s[36:39], s91 offen offset:1024 sc1 lds
    v_mfma_f32_16x16x32_bf16 v[68:71], a[232:235], a[176:179], v[68:71]
    ds_read_b128 a[148:151], v145 offset:2048
    v_mfma_f32_16x16x32_bf16 v[72:75], a[232:235], a[184:187], v[72:75]
    ds_read_b128 a[152:155], v144 offset:11264
    s_add_u32 m0, s58, 0
    v_mfma_f32_16x16x32_bf16 v[72:75], a[236:239], a[188:191], v[72:75]
    s_add_u32 s53, s59, 0
    buffer_load_dwordx4 v218, s[60:63], s53 offen offset:0 lds
    v_mfma_f32_16x16x32_bf16 v[76:79], a[236:239], a[196:199], v[76:79]
    ds_read_b128 a[156:159], v145 offset:11264
    v_mfma_f32_16x16x32_bf16 v[76:79], a[232:235], a[192:195], v[76:79]
    s_movk_i32 s78, 3072
    v_mfma_f32_16x16x32_bf16 v[92:95], a[240:243], a[192:195], v[92:95]
    ds_read_b128 a[160:163], v144 offset:13312
    s_lshl_b32 s89, s82, 10
    v_mfma_f32_16x16x32_bf16 v[92:95], a[244:247], a[196:199], v[92:95]
    buffer_load_dwordx4 v219, s[60:63], s53 offen offset:1024 lds
    v_mfma_f32_16x16x32_bf16 v[88:91], a[244:247], a[188:191], v[88:91]
    ds_read_b128 a[164:167], v145 offset:13312
    v_mfma_f32_16x16x32_bf16 v[88:91], a[240:243], a[184:187], v[88:91]
    ds_read_b64_tr_b16 a[208:209], v149 offset:5120
    v_mfma_f32_16x16x32_bf16 v[84:87], a[240:243], a[176:179], v[84:87]
    s_add_u32 m0, s96, 90112
    s_add_u32 s53, s81, 0
    v_mfma_f32_16x16x32_bf16 v[84:87], a[244:247], a[180:183], v[84:87]
    buffer_load_dwordx4 v218, s[60:63], s53 offen offset:0 lds
    v_mfma_f32_16x16x32_bf16 v[80:83], a[244:247], a[172:175], v[80:83]
    ds_read_b64_tr_b16 a[210:211], v149 offset:5376
    v_mov_b32_e64 v233, v254
    v_mfma_f32_16x16x32_bf16 v[80:83], a[240:243], a[168:171], v[80:83]
    ds_read_b64_tr_b16 a[212:213], v149 offset:27648
    v_mfma_f32_16x16x32_bf16 v[96:99], a[248:251], a[168:171], v[96:99]
    buffer_load_dwordx4 v219, s[60:63], s53 offen offset:1024 lds
    v_mfma_f32_16x16x32_bf16 v[96:99], a[252:255], a[172:175], v[96:99]
    ds_read_b64_tr_b16 a[214:215], v149 offset:27904
    v_mfma_f32_16x16x32_bf16 v[100:103], a[252:255], a[180:183], v[100:103]
    ds_read_b64_tr_b16 a[216:217], v148 offset:7168
    v_mfma_f32_16x16x32_bf16 v[100:103], a[248:251], a[176:179], v[100:103]
    s_add_u32 m0, s96, 92160
    s_add_u32 s53, s81, 16384
    v_mfma_f32_16x16x32_bf16 v[104:107], a[248:251], a[184:187], v[104:107]
    buffer_load_dwordx4 v218, s[60:63], s53 offen offset:0 lds
    v_mfma_f32_16x16x32_bf16 v[104:107], a[252:255], a[188:191], v[104:107]
    ds_read_b64_tr_b16 a[218:219], v148 offset:7424
    v_mfma_f32_16x16x32_bf16 v[108:111], a[252:255], a[196:199], v[108:111]
    ds_read_b64_tr_b16 a[220:221], v148 offset:29696
    v_add_u32_e64 v229, s89, v233
    v_mfma_f32_16x16x32_bf16 v[108:111], a[248:251], a[192:195], v[108:111]
    ds_read_b64_tr_b16 a[222:223], v148 offset:29952
    s_waitcnt lgkmcnt(8)
    v_mfma_f32_16x16x32_bf16 v[0:3], a[200:203], a[136:139], v[0:3]
    ds_read_b64_tr_b16 a[224:225], v149 offset:7168
    v_mfma_f32_16x16x32_bf16 v[0:3], a[204:207], a[140:143], v[0:3]
    ds_read_b64_tr_b16 a[226:227], v149 offset:7424
    ds_read_b64_tr_b16 a[228:229], v149 offset:29696
    v_mfma_f32_16x16x32_bf16 v[4:7], a[204:207], a[148:151], v[4:7]
    buffer_load_dwordx4 v219, s[60:63], s53 offen offset:1024 lds
    v_mfma_f32_16x16x32_bf16 v[4:7], a[200:203], a[144:147], v[4:7]
    ds_read_b64_tr_b16 a[230:231], v149 offset:29952
    v_mfma_f32_16x16x32_bf16 v[8:11], a[200:203], a[152:155], v[8:11]
    ds_read_b64_tr_b16 a[232:233], v148 offset:9216
    v_mfma_f32_16x16x32_bf16 v[8:11], a[204:207], a[156:159], v[8:11]
    ds_read_b64_tr_b16 a[234:235], v148 offset:9472
    v_mfma_f32_16x16x32_bf16 v[12:15], a[204:207], a[164:167], v[12:15]
    ds_read_b64_tr_b16 a[236:237], v148 offset:31744
    ds_read_b64_tr_b16 a[238:239], v148 offset:32000
    v_mfma_f32_16x16x32_bf16 v[12:15], a[200:203], a[160:163], v[12:15]
    s_add_u32 m0, s96, 94208
    s_add_u32 s53, s94, 0
    s_waitcnt lgkmcnt(12)
    v_mfma_f32_16x16x32_bf16 v[28:31], a[208:211], a[160:163], v[28:31]
    buffer_load_dwordx4 v218, s[60:63], s53 offen offset:0 lds
    v_mfma_f32_16x16x32_bf16 v[28:31], a[212:215], a[164:167], v[28:31]
    ds_read_b64_tr_b16 a[240:241], v149 offset:9216
    v_mfma_f32_16x16x32_bf16 v[24:27], a[212:215], a[156:159], v[24:27]
    ds_read_b64_tr_b16 a[242:243], v149 offset:9472
    ds_read_b64_tr_b16 a[244:245], v149 offset:31744
    v_mfma_f32_16x16x32_bf16 v[24:27], a[208:211], a[152:155], v[24:27]
    ds_read_b64_tr_b16 a[246:247], v149 offset:32000
    v_mfma_f32_16x16x32_bf16 v[20:23], a[208:211], a[144:147], v[20:23]
    ds_read_b64_tr_b16 a[248:249], v150 offset:4096
    v_xor_b32 v230, 1024, v229
    v_mfma_f32_16x16x32_bf16 v[20:23], a[212:215], a[148:151], v[20:23]
    ds_read_b64_tr_b16 a[250:251], v150 offset:4352
    v_mfma_f32_16x16x32_bf16 v[16:19], a[212:215], a[140:143], v[16:19]
    ds_read_b64_tr_b16 a[252:253], v150 offset:26624
    v_mfma_f32_16x16x32_bf16 v[16:19], a[208:211], a[136:139], v[16:19]
    ds_read_b64_tr_b16 a[254:255], v150 offset:26880
    s_waitcnt lgkmcnt(14)
    v_mfma_f32_16x16x32_bf16 v[32:35], a[216:219], a[136:139], v[32:35]
    buffer_load_dwordx4 v219, s[60:63], s53 offen offset:1024 lds
    v_mfma_f32_16x16x32_bf16 v[32:35], a[220:223], a[140:143], v[32:35]
    s_add_u32 m0, s96, 96256
    s_add_u32 s53, s94, 16384
    buffer_load_dwordx4 v218, s[60:63], s53 offen offset:0 lds
    v_mfma_f32_16x16x32_bf16 v[36:39], a[220:223], a[148:151], v[36:39]
    v_xor_b32 v231, 2048, v229
    v_mfma_f32_16x16x32_bf16 v[36:39], a[216:219], a[144:147], v[36:39]
    buffer_load_dwordx4 v219, s[60:63], s53 offen offset:1024 lds
    v_mfma_f32_16x16x32_bf16 v[40:43], a[216:219], a[152:155], v[40:43]
    s_add_u32 m0, s96, 98304
    s_add_u32 s53, s95, 0
    v_mfma_f32_16x16x32_bf16 v[40:43], a[220:223], a[156:159], v[40:43]
    buffer_load_dwordx4 v218, s[60:63], s53 offen offset:0 lds
    v_mfma_f32_16x16x32_bf16 v[44:47], a[220:223], a[164:167], v[44:47]
    v_xor_b32 v232, 3072, v229
    v_mfma_f32_16x16x32_bf16 v[44:47], a[216:219], a[160:163], v[44:47]
    buffer_load_dwordx4 v219, s[60:63], s53 offen offset:1024 lds
    s_waitcnt vmcnt(12) lgkmcnt(0)
    s_barrier
    v_mfma_f32_16x16x32_bf16 v[60:63], a[224:227], a[160:163], v[60:63]
    ds_read_b64_tr_b16 a[200:201], v151 offset:5120
    v_mfma_f32_16x16x32_bf16 v[60:63], a[228:231], a[164:167], v[60:63]
    ds_read_b64 v[176:177], v159 offset:0
    s_add_u32 m0, s58, 2048
    v_mfma_f32_16x16x32_bf16 v[56:59], a[228:231], a[156:159], v[56:59]
    s_add_u32 s53, s59, 16384
    buffer_load_dwordx4 v218, s[60:63], s53 offen offset:0 lds
    v_mfma_f32_16x16x32_bf16 v[56:59], a[224:227], a[152:155], v[56:59]
    ds_read_b64_tr_b16 a[202:203], v151 offset:5376
    v_mfma_f32_16x16x32_bf16 v[52:55], a[224:227], a[144:147], v[52:55]
    ds_read_b64_tr_b16 a[204:205], v151 offset:27648
    v_mfma_f32_16x16x32_bf16 v[52:55], a[228:231], a[148:151], v[52:55]
    ds_read_b64 v[178:179], v159 offset:8
    buffer_load_dwordx4 v219, s[60:63], s53 offen offset:1024 lds
    v_mfma_f32_16x16x32_bf16 v[48:51], a[228:231], a[140:143], v[48:51]
    ds_read_b64_tr_b16 a[206:207], v151 offset:27904
    v_mfma_f32_16x16x32_bf16 v[48:51], a[224:227], a[136:139], v[48:51]
    ds_read_b128 a[168:171], v144 offset:45056
    v_mfma_f32_16x16x32_bf16 v[64:67], a[232:235], a[136:139], v[64:67]
    ds_read_b64 v[180:181], v159 offset:256
    s_add_u32 m0, s96, 0
    v_mfma_f32_16x16x32_bf16 v[64:67], a[236:239], a[140:143], v[64:67]
    s_add_u32 s53, s95, 16384
    buffer_load_dwordx4 v218, s[60:63], s53 offen offset:0 lds
    v_mfma_f32_16x16x32_bf16 v[68:71], a[236:239], a[148:151], v[68:71]
    ds_read_b128 a[172:175], v145 offset:45056
    v_mfma_f32_16x16x32_bf16 v[68:71], a[232:235], a[144:147], v[68:71]
    ds_read_b64 v[182:183], v159 offset:264
    v_mfma_f32_16x16x32_bf16 v[72:75], a[232:235], a[152:155], v[72:75]
    ds_read_b128 a[176:179], v144 offset:47104
    ds_read_b128 a[180:183], v145 offset:47104
    v_mfma_f32_16x16x32_bf16 v[72:75], a[236:239], a[156:159], v[72:75]
    ds_read2st64_b32 v[162:163], v140 offset0:0 offset1:1
    v_mfma_f32_16x16x32_bf16 v[76:79], a[236:239], a[164:167], v[76:79]
    ds_read_b128 a[184:187], v144 offset:56320
    buffer_load_dwordx4 v219, s[60:63], s53 offen offset:1024 lds
    v_mfma_f32_16x16x32_bf16 v[76:79], a[232:235], a[160:163], v[76:79]
    ds_read_b128 a[188:191], v145 offset:56320
    v_mfma_f32_16x16x32_bf16 v[92:95], a[240:243], a[160:163], v[92:95]
    ds_read2st64_b32 v[164:165], v141 offset0:0 offset1:1
    v_mfma_f32_16x16x32_bf16 v[92:95], a[244:247], a[164:167], v[92:95]
    ds_read_b128 a[192:195], v144 offset:58368
    s_add_u32 m0, s96, 2048
    v_mfma_f32_16x16x32_bf16 v[88:91], a[244:247], a[156:159], v[88:91]
    s_xor_b32 s53, s93, 196608
    buffer_load_dwordx4 v220, s[60:63], s53 offen offset:0 lds
    v_mfma_f32_16x16x32_bf16 v[88:91], a[240:243], a[152:155], v[88:91]
    ds_read_b128 a[196:199], v145 offset:58368
    v_mfma_f32_16x16x32_bf16 v[84:87], a[240:243], a[144:147], v[84:87]
    ds_read2st64_b32 v[166:167], v140 offset0:5 offset1:6
    v_mfma_f32_16x16x32_bf16 v[84:87], a[244:247], a[148:151], v[84:87]
    ds_read_b64_tr_b16 a[208:209], v152 offset:5120
    buffer_load_dwordx4 v221, s[60:63], s53 offen offset:1024 lds
    v_mfma_f32_16x16x32_bf16 v[80:83], a[244:247], a[140:143], v[80:83]
    ds_read_b64_tr_b16 a[210:211], v152 offset:5376
    v_mfma_f32_16x16x32_bf16 v[80:83], a[240:243], a[136:139], v[80:83]
    ds_read2st64_b32 v[168:169], v141 offset0:5 offset1:6
    v_mfma_f32_16x16x32_bf16 v[96:99], a[248:251], a[136:139], v[96:99]
    ds_read_b64_tr_b16 a[212:213], v152 offset:27648
    v_mfma_f32_16x16x32_bf16 v[96:99], a[252:255], a[140:143], v[96:99]
    ds_read2st64_b32 v[170:171], v140 offset0:10 offset1:11
    ds_read_b64_tr_b16 a[214:215], v152 offset:27904
    v_mfma_f32_16x16x32_bf16 v[100:103], a[252:255], a[148:151], v[100:103]
    ds_read_b64_tr_b16 a[216:217], v151 offset:7168
    v_mfma_f32_16x16x32_bf16 v[100:103], a[248:251], a[144:147], v[100:103]
    ds_read2st64_b32 v[172:173], v141 offset0:10 offset1:11
    ds_read_b64_tr_b16 a[218:219], v151 offset:7424
    v_mfma_f32_16x16x32_bf16 v[104:107], a[248:251], a[152:155], v[104:107]
    ds_read_b64_tr_b16 a[220:221], v151 offset:29696
    s_add_u32 m0, s96, 4096
    v_mfma_f32_16x16x32_bf16 v[104:107], a[252:255], a[156:159], v[104:107]
    s_xor_b32 s53, s93, 200704
    v_mfma_f32_16x16x32_bf16 v[108:111], a[252:255], a[164:167], v[108:111]
    buffer_load_dwordx4 v220, s[60:63], s53 offen offset:0 lds
    v_mfma_f32_16x16x32_bf16 v[108:111], a[248:251], a[160:163], v[108:111]
    ds_read2st64_b32 v[174:175], v142 offset0:0 offset1:1
    ds_read_b64_tr_b16 a[222:223], v151 offset:29952
    s_waitcnt lgkmcnt(13)
    v_mfma_f32_16x16x32_bf16 v[0:3], a[200:203], a[168:171], v[0:3]
    ds_read_b64_tr_b16 a[224:225], v152 offset:7168
    v_cmp_gt_u32 vcc, 32, v255
    v_mfma_f32_16x16x32_bf16 v[0:3], a[204:207], a[172:175], v[0:3]
    ds_read_b64_tr_b16 a[226:227], v152 offset:7424
    v_cmp_gt_u32 s[90:91], 48, v255
    v_mfma_f32_16x16x32_bf16 v[4:7], a[204:207], a[180:183], v[4:7]
    ds_read_b64_tr_b16 a[228:229], v152 offset:29696
    v_rcp_f32_e64 v200, v177
    v_mfma_f32_16x16x32_bf16 v[4:7], a[200:203], a[176:179], v[4:7]
    ds_read_b64_tr_b16 a[230:231], v152 offset:29952
    buffer_load_dwordx4 v221, s[60:63], s53 offen offset:1024 lds
    v_mfma_f32_16x16x32_bf16 v[8:11], a[200:203], a[184:187], v[8:11]
    ds_read_b64_tr_b16 a[232:233], v151 offset:9216
    v_rcp_f32 v201, v179
    v_rcp_f32 v202, v181
    v_mfma_f32_16x16x32_bf16 v[8:11], a[204:207], a[188:191], v[8:11]
    ds_read_b64_tr_b16 a[234:235], v151 offset:9472
    v_rcp_f32_e64 v203, v183
    v_mfma_f32_16x16x32_bf16 v[12:15], a[204:207], a[196:199], v[12:15]
    ds_read_b64_tr_b16 a[236:237], v151 offset:31744
    v_cvt_pk_bf16_f32 v204, v176, v176
    v_mfma_f32_16x16x32_bf16 v[12:15], a[200:203], a[192:195], v[12:15]
    ds_read_b64_tr_b16 a[238:239], v151 offset:32000
    ds_read_b64_tr_b16 a[240:241], v152 offset:9216
    s_waitcnt lgkmcnt(14)
    v_mfma_f32_16x16x32_bf16 v[28:31], a[208:211], a[192:195], v[28:31]
    ds_read_b64_tr_b16 a[242:243], v152 offset:9472
    v_cvt_pk_bf16_f32 v205, v178, v178
    v_cvt_pk_bf16_f32 v206, v180, v180
    v_mfma_f32_16x16x32_bf16 v[28:31], a[212:215], a[196:199], v[28:31]
    ds_read_b64_tr_b16 a[244:245], v152 offset:31744
    v_cvt_pk_bf16_f32 v207, v182, v182
    v_mfma_f32_16x16x32_bf16 v[24:27], a[212:215], a[188:191], v[24:27]
    ds_read_b64_tr_b16 a[246:247], v152 offset:32000
    s_waitcnt vmcnt(18)
    ds_read_b64_tr_b16 a[0:1], v226 offset:0
    ds_read_b64_tr_b16 a[4:5], v227 offset:0
    v_mfma_f32_16x16x32_bf16 v[24:27], a[208:211], a[184:187], v[24:27]
    ds_read_b64_tr_b16 a[248:249], v153 offset:4096
    v_cvt_pk_bf16_f32 v185, v200, 0
    v_mfma_f32_16x16x32_bf16 v[20:23], a[208:211], a[176:179], v[20:23]
    ds_read_b64_tr_b16 a[250:251], v153 offset:4352
    v_cvt_pk_bf16_f32 v187, v201, 0
    v_cvt_pk_bf16_f32 v189, v202, 0
    v_mfma_f32_16x16x32_bf16 v[20:23], a[212:215], a[180:183], v[20:23]
    ds_read_b64_tr_b16 a[252:253], v153 offset:26624
    ds_read_b64_tr_b16 a[254:255], v153 offset:26880
    v_cvt_pk_bf16_f32 v191, v203, 0
    v_mfma_f32_16x16x32_bf16 v[16:19], a[212:215], a[172:175], v[16:19]
    s_add_u32 m0, s96, 6144
    s_xor_b32 s53, s93, 229376
    buffer_load_dwordx4 v220, s[60:63], s53 offen offset:0 lds
    v_mfma_f32_16x16x32_bf16 v[16:19], a[208:211], a[168:171], v[16:19]
    buffer_load_dwordx4 v221, s[60:63], s53 offen offset:1024 lds
    s_add_u32 m0, s96, 8192
    s_waitcnt lgkmcnt(14)
    v_mfma_f32_16x16x32_bf16 v[32:35], a[216:219], a[168:171], v[32:35]
    s_xor_b32 s53, s93, 233472
    buffer_load_dwordx4 v220, s[60:63], s53 offen offset:0 lds
    ds_read_b64_tr_b16 a[8:9], v226 offset:512
    v_mfma_f32_16x16x32_bf16 v[32:35], a[220:223], a[172:175], v[32:35]
    ds_read_b64_tr_b16 a[12:13], v227 offset:512
    buffer_load_dwordx4 v221, s[60:63], s53 offen offset:1024 lds
    v_mfma_f32_16x16x32_bf16 v[36:39], a[220:223], a[180:183], v[36:39]
    v_cndmask_b32 v184, 0, v204, vcc
    v_cndmask_b32 v186, 0, v205, vcc
    v_mfma_f32_16x16x32_bf16 v[36:39], a[216:219], a[176:179], v[36:39]
    v_cndmask_b32 v188, 0, v206, vcc
    v_cndmask_b32 v190, 0, v207, vcc
    v_lshlrev_b32 v176, 16, v185
    v_mfma_f32_16x16x32_bf16 v[40:43], a[216:219], a[184:187], v[40:43]
    v_lshlrev_b32 v178, 16, v187
    v_lshlrev_b32 v180, 16, v189
    v_lshlrev_b32_e64 v182, 16, v191
    v_mfma_f32_16x16x32_bf16 v[40:43], a[220:223], a[188:191], v[40:43]
    v_cndmask_b32 v185, 0, v185, s[90:91]
    v_cndmask_b32 v187, 0, v187, s[90:91]
    v_mfma_f32_16x16x32_bf16 v[44:47], a[220:223], a[196:199], v[44:47]
    v_cndmask_b32 v189, 0, v189, s[90:91]
    v_cndmask_b32 v191, 0, v191, s[90:91]
    v_cndmask_b32 v185, v185, v204, vcc
    v_mfma_f32_16x16x32_bf16 v[44:47], a[216:219], a[192:195], v[44:47]
    v_cndmask_b32 v187, v187, v205, vcc
    v_cndmask_b32 v189, v189, v206, vcc
    v_cndmask_b32 v191, v191, v207, vcc
    s_waitcnt lgkmcnt(2)
    s_barrier
    v_mfma_f32_16x16x16_bf16 v[48:51], v[168:169], v[184:185], v[48:51]
    v_mul_f32 v193, 0xc0135761, v177
    v_mfma_f32_16x16x16_bf16 v[52:55], v[168:169], v[186:187], v[52:55]
    s_waitcnt vmcnt(20)
    ds_read_b64_tr_b16 a[16:17], v224 offset:0
    v_mfma_f32_16x16x16_bf16 v[56:59], v[168:169], v[188:189], v[56:59]
    ds_read_b64_tr_b16 a[20:21], v225 offset:0
    v_mfma_f32_16x16x16_bf16 v[60:63], v[168:169], v[190:191], v[60:63]
    ds_read_b64_tr_b16 a[24:25], v224 offset:512
    v_mfma_f32_16x16x16_bf16 v[64:67], v[170:171], v[184:185], v[64:67]
    ds_read_b64_tr_b16 a[28:29], v225 offset:512
    s_add_u32 m0, s96, 45056
    v_mfma_f32_16x16x16_bf16 v[68:71], v[170:171], v[186:187], v[68:71]
    s_add_u32 s53, s59, 65536
    v_mfma_f32_16x16x16_bf16 v[72:75], v[170:171], v[188:189], v[72:75]
    buffer_load_dwordx4 v218, s[60:63], s53 offen offset:0 lds
    v_mfma_f32_16x16x16_bf16 v[76:79], v[170:171], v[190:191], v[76:79]
    buffer_load_dwordx4 v219, s[60:63], s53 offen offset:1024 lds
    v_mfma_f32_16x16x16_bf16 v[80:83], v[172:173], v[184:185], v[80:83]
    s_waitcnt vmcnt(20)
    ds_read_b64_tr_b16 a[18:19], v224 offset:2048
    v_mul_f32 v195, 0xc0135761, v179
    v_mfma_f32_16x16x16_bf16 v[84:87], v[172:173], v[186:187], v[84:87]
    ds_read_b64_tr_b16 a[22:23], v225 offset:2048
    v_mfma_f32_16x16x16_bf16 v[88:91], v[172:173], v[188:189], v[88:91]
    ds_read_b64_tr_b16 a[26:27], v224 offset:2560
    v_mfma_f32_16x16x16_bf16 v[92:95], v[172:173], v[190:191], v[92:95]
    ds_read_b64_tr_b16 a[30:31], v225 offset:2560
    v_mul_f32 v197, 0xc0135761, v181
    v_mfma_f32_16x16x16_bf16 v[96:99], v[174:175], v[184:185], v[96:99]
    s_add_u32 m0, s96, 47104
    s_add_u32 s53, s59, 81920
    v_mfma_f32_16x16x16_bf16 v[100:103], v[174:175], v[186:187], v[100:103]
    buffer_load_dwordx4 v218, s[60:63], s53 offen offset:0 lds
    v_mfma_f32_16x16x16_bf16 v[104:107], v[174:175], v[188:189], v[104:107]
    buffer_load_dwordx4 v219, s[60:63], s53 offen offset:1024 lds
    v_mfma_f32_16x16x16_bf16 v[108:111], v[174:175], v[190:191], v[108:111]
    s_waitcnt vmcnt(20)
    ds_read_b64_tr_b16 a[32:33], v224 offset:4096
    v_mul_f32 v199, 0xc0135761, v183
    v_mfma_f32_16x16x16_bf16 v[0:3], v[162:163], v[184:185], v[0:3]
    ds_read_b64_tr_b16 a[36:37], v225 offset:4096
    v_mfma_f32_16x16x16_bf16 v[4:7], v[162:163], v[186:187], v[4:7]
    ds_read_b64_tr_b16 a[40:41], v224 offset:4608
    v_mfma_f32_16x16x16_bf16 v[8:11], v[162:163], v[188:189], v[8:11]
    ds_read_b64_tr_b16 a[44:45], v225 offset:4608
    v_mul_f32 v200, v177, v177
    v_mfma_f32_16x16x16_bf16 v[12:15], v[162:163], v[190:191], v[12:15]
    s_waitcnt vmcnt(18)
    ds_read_b64_tr_b16 a[34:35], v224 offset:6144
    v_mul_f32 v201, v179, v179
    v_mfma_f32_16x16x16_bf16 v[16:19], v[164:165], v[184:185], v[16:19]
    ds_read_b64_tr_b16 a[38:39], v225 offset:6144
    v_mfma_f32_16x16x16_bf16 v[20:23], v[164:165], v[186:187], v[20:23]
    ds_read_b64_tr_b16 a[42:43], v224 offset:6656
    v_mfma_f32_16x16x16_bf16 v[24:27], v[164:165], v[188:189], v[24:27]
    ds_read_b64_tr_b16 a[46:47], v225 offset:6656
    s_add_u32 m0, s96, 49152
    v_mfma_f32_16x16x16_bf16 v[28:31], v[164:165], v[190:191], v[28:31]
    s_add_u32 s53, s81, 65536
    v_mfma_f32_16x16x16_bf16 v[32:35], v[166:167], v[184:185], v[32:35]
    buffer_load_dwordx4 v218, s[60:63], s53 offen offset:0 lds
    v_mfma_f32_16x16x16_bf16 v[36:39], v[166:167], v[186:187], v[36:39]
    buffer_load_dwordx4 v219, s[60:63], s53 offen offset:1024 lds
    v_mfma_f32_16x16x16_bf16 v[40:43], v[166:167], v[188:189], v[40:43]
    s_waitcnt vmcnt(18)
    ds_read_b64_tr_b16 a[48:49], v224 offset:8192
    v_mul_f32 v202, v181, v181
    v_mfma_f32_16x16x16_bf16 v[44:47], v[166:167], v[190:191], v[44:47]
    ds_read_b64_tr_b16 a[52:53], v225 offset:8192
    v_mfma_f32_16x16x32_bf16 v[60:63], a[224:227], a[192:195], v[60:63]
    ds_read_b64_tr_b16 a[56:57], v224 offset:8704
    v_mfma_f32_16x16x32_bf16 v[60:63], a[228:231], a[196:199], v[60:63]
    ds_read_b64_tr_b16 a[60:61], v225 offset:8704
    v_mul_f32_e64 v203, v183, v183
    v_mfma_f32_16x16x32_bf16 v[56:59], a[228:231], a[188:191], v[56:59]
    s_add_u32 m0, s96, 51200
    s_add_u32 s53, s81, 81920
    v_mfma_f32_16x16x32_bf16 v[56:59], a[224:227], a[184:187], v[56:59]
    buffer_load_dwordx4 v218, s[60:63], s53 offen offset:0 lds
    v_mfma_f32_16x16x32_bf16 v[52:55], a[224:227], a[176:179], v[52:55]
    buffer_load_dwordx4 v219, s[60:63], s53 offen offset:1024 lds
    v_mfma_f32_16x16x32_bf16 v[52:55], a[228:231], a[180:183], v[52:55]
    v_mul_f32 v192, 0x3d372713, v193
    v_mfma_f32_16x16x32_bf16 v[48:51], a[228:231], a[172:175], v[48:51]
    s_waitcnt vmcnt(16)
    ds_read_b64_tr_b16 a[50:51], v222 offset:0
    v_mfma_f32_16x16x32_bf16 v[48:51], a[224:227], a[168:171], v[48:51]
    ds_read_b64_tr_b16 a[54:55], v223 offset:0
    v_mfma_f32_16x16x32_bf16 v[64:67], a[232:235], a[168:171], v[64:67]
    ds_read_b64_tr_b16 a[58:59], v222 offset:512
    v_mfma_f32_16x16x32_bf16 v[64:67], a[236:239], a[172:175], v[64:67]
    ds_read_b64_tr_b16 a[62:63], v223 offset:512
    v_mul_f32 v194, 0x3d372713, v195
    v_mfma_f32_16x16x32_bf16 v[68:71], a[236:239], a[180:183], v[68:71]
    s_add_u32 m0, s96, 53248
    s_add_u32 s53, s94, 65536
    v_mfma_f32_16x16x32_bf16 v[68:71], a[232:235], a[176:179], v[68:71]
    buffer_load_dwordx4 v218, s[60:63], s53 offen offset:0 lds
    v_mfma_f32_16x16x32_bf16 v[72:75], a[232:235], a[184:187], v[72:75]
    buffer_load_dwordx4 v219, s[60:63], s53 offen offset:1024 lds
    v_mfma_f32_16x16x32_bf16 v[72:75], a[236:239], a[188:191], v[72:75]
    s_waitcnt vmcnt(16)
    ds_read_b64_tr_b16 a[64:65], v222 offset:2048
    v_mfma_f32_16x16x32_bf16 v[76:79], a[236:239], a[196:199], v[76:79]
    ds_read_b64_tr_b16 a[68:69], v223 offset:2048
    v_mfma_f32_16x16x32_bf16 v[76:79], a[232:235], a[192:195], v[76:79]
    ds_read_b64_tr_b16 a[72:73], v222 offset:2560
    v_mfma_f32_16x16x32_bf16 v[92:95], a[240:243], a[192:195], v[92:95]
    ds_read_b64_tr_b16 a[76:77], v223 offset:2560
    v_mul_f32 v196, 0x3d372713, v197
    v_mfma_f32_16x16x32_bf16 v[92:95], a[244:247], a[196:199], v[92:95]
    s_waitcnt vmcnt(14)
    ds_read_b64_tr_b16 a[66:67], v222 offset:4096
    v_mul_f32 v198, 0x3d372713, v199
    v_mfma_f32_16x16x32_bf16 v[88:91], a[244:247], a[188:191], v[88:91]
    ds_read_b64_tr_b16 a[70:71], v223 offset:4096
    v_mfma_f32_16x16x32_bf16 v[88:91], a[240:243], a[184:187], v[88:91]
    ds_read_b64_tr_b16 a[74:75], v222 offset:4608
    v_mfma_f32_16x16x32_bf16 v[84:87], a[240:243], a[176:179], v[84:87]
    ds_read_b64_tr_b16 a[78:79], v223 offset:4608
    v_mul_f32 v192, v192, v200
    v_mfma_f32_16x16x32_bf16 v[84:87], a[244:247], a[180:183], v[84:87]
    s_add_u32 m0, s96, 90112
    s_add_u32 s53, s94, 81920
    v_mfma_f32_16x16x32_bf16 v[80:83], a[244:247], a[172:175], v[80:83]
    s_waitcnt lgkmcnt(14)
    buffer_load_dwordx4 v218, s[60:63], s53 offen offset:0 lds
    v_mfma_f32_16x16x32_bf16 v[80:83], a[240:243], a[168:171], v[80:83]
    buffer_load_dwordx4 v219, s[60:63], s53 offen offset:1024 lds
    v_mfma_f32_16x16x32_bf16 v[96:99], a[248:251], a[168:171], v[96:99]
    ds_read_b64_tr_b16 a[2:3], v226 offset:2048
    v_mul_f32 v194, v194, v201
    v_mfma_f32_16x16x32_bf16 v[96:99], a[252:255], a[172:175], v[96:99]
    ds_read_b64_tr_b16 a[6:7], v227 offset:2048
    v_mfma_f32_16x16x32_bf16 v[100:103], a[252:255], a[180:183], v[100:103]
    v_mul_f32_e64 v196, v196, v202
    v_mfma_f32_16x16x32_bf16 v[100:103], a[248:251], a[176:179], v[100:103]
    s_add_u32 m0, s96, 92160
    s_add_u32 s53, s95, 65536
    v_mfma_f32_16x16x32_bf16 v[104:107], a[248:251], a[184:187], v[104:107]
    buffer_load_dwordx4 v218, s[60:63], s53 offen offset:0 lds
    v_mfma_f32_16x16x32_bf16 v[104:107], a[252:255], a[188:191], v[104:107]
    buffer_load_dwordx4 v219, s[60:63], s53 offen offset:1024 lds
    v_mfma_f32_16x16x32_bf16 v[108:111], a[252:255], a[196:199], v[108:111]
    ds_read_b64_tr_b16 a[10:11], v226 offset:2560
    v_mfma_f32_16x16x32_bf16 v[108:111], a[248:251], a[192:195], v[108:111]
    ds_read_b64_tr_b16 a[14:15], v227 offset:2560
    v_mul_f32_e64 v198, v198, v203
    v_pk_mul_f32 v[112:113], v[0:1], v[0:1]
    v_pk_mul_f32 v[114:115], v[2:3], v[2:3]
    v_pk_mul_f32 v[116:117], v[16:17], v[16:17]
    v_pk_mul_f32 v[118:119], v[18:19], v[18:19]
    v_pk_fma_f32 v[112:113], v[112:113], v[192:193], v[192:193] op_sel:[0,0,1] op_sel_hi:[1,0,1]
    v_pk_fma_f32 v[114:115], v[114:115], v[192:193], v[192:193] op_sel:[0,0,1] op_sel_hi:[1,0,1]
    v_pk_fma_f32 v[116:117], v[116:117], v[192:193], v[192:193] op_sel:[0,0,1] op_sel_hi:[1,0,1]
    v_pk_fma_f32 v[118:119], v[118:119], v[192:193], v[192:193] op_sel:[0,0,1] op_sel_hi:[1,0,1]
    v_pk_mul_f32 v[112:113], v[112:113], v[0:1]
    v_pk_mul_f32 v[114:115], v[114:115], v[2:3]
    v_pk_mul_f32 v[116:117], v[116:117], v[16:17]
    v_pk_mul_f32 v[118:119], v[118:119], v[18:19]
    v_exp_f32 v112, v112
    v_exp_f32 v113, v113
    v_exp_f32 v114, v114
    v_exp_f32 v115, v115
    v_exp_f32 v116, v116
    v_exp_f32 v117, v117
    v_exp_f32 v118, v118
    v_exp_f32 v119, v119
    v_pk_fma_f32 v[112:113], v[112:113], v[176:177], v[176:177] op_sel_hi:[1,0,0]
    v_pk_fma_f32 v[114:115], v[114:115], v[176:177], v[176:177] op_sel_hi:[1,0,0]
    v_pk_fma_f32 v[116:117], v[116:117], v[176:177], v[176:177] op_sel_hi:[1,0,0]
    v_pk_fma_f32 v[118:119], v[118:119], v[176:177], v[176:177] op_sel_hi:[1,0,0]
    v_rcp_f32 v112, v112
    v_rcp_f32 v113, v113
    v_rcp_f32 v114, v114
    v_rcp_f32 v115, v115
    v_rcp_f32 v116, v116
    v_rcp_f32 v117, v117
    v_rcp_f32 v118, v118
    v_rcp_f32 v119, v119
    v_pk_mul_f32 v[112:113], v[112:113], v[0:1]
    v_pk_mul_f32 v[114:115], v[114:115], v[2:3]
    v_pk_mul_f32 v[116:117], v[116:117], v[16:17]
    v_pk_mul_f32 v[118:119], v[118:119], v[18:19]
    v_cvt_pk_bf16_f32 v0, v112, v113
    v_cvt_pk_bf16_f32 v1, v114, v115
    v_cvt_pk_bf16_f32 v2, v116, v117
    v_cvt_pk_bf16_f32 v3, v118, v119
    buffer_store_dwordx4 v[0:3], v233, s[36:39], s97 offen offset:0 sc1
    v_pk_mul_f32 v[120:121], v[4:5], v[4:5]
    v_pk_mul_f32 v[122:123], v[6:7], v[6:7]
    v_pk_mul_f32 v[124:125], v[20:21], v[20:21]
    v_pk_mul_f32 v[126:127], v[22:23], v[22:23]
    v_pk_fma_f32 v[120:121], v[120:121], v[194:195], v[194:195] op_sel:[0,0,1] op_sel_hi:[1,0,1]
    v_pk_fma_f32 v[122:123], v[122:123], v[194:195], v[194:195] op_sel:[0,0,1] op_sel_hi:[1,0,1]
    v_pk_fma_f32 v[124:125], v[124:125], v[194:195], v[194:195] op_sel:[0,0,1] op_sel_hi:[1,0,1]
    v_pk_fma_f32 v[126:127], v[126:127], v[194:195], v[194:195] op_sel:[0,0,1] op_sel_hi:[1,0,1]
    v_pk_mul_f32 v[120:121], v[120:121], v[4:5]
    v_pk_mul_f32 v[122:123], v[122:123], v[6:7]
    v_pk_mul_f32 v[124:125], v[124:125], v[20:21]
    v_pk_mul_f32 v[126:127], v[126:127], v[22:23]
    v_exp_f32 v120, v120
    v_exp_f32 v121, v121
    v_exp_f32 v122, v122
    v_exp_f32 v123, v123
    v_exp_f32 v124, v124
    v_exp_f32 v125, v125
    v_exp_f32 v126, v126
    v_exp_f32 v127, v127
    v_pk_fma_f32 v[120:121], v[120:121], v[178:179], v[178:179] op_sel_hi:[1,0,0]
    v_pk_fma_f32 v[122:123], v[122:123], v[178:179], v[178:179] op_sel_hi:[1,0,0]
    v_pk_fma_f32 v[124:125], v[124:125], v[178:179], v[178:179] op_sel_hi:[1,0,0]
    v_pk_fma_f32 v[126:127], v[126:127], v[178:179], v[178:179] op_sel_hi:[1,0,0]
    v_rcp_f32 v120, v120
    v_rcp_f32 v121, v121
    v_rcp_f32 v122, v122
    v_rcp_f32 v123, v123
    v_rcp_f32 v124, v124
    v_rcp_f32 v125, v125
    v_rcp_f32 v126, v126
    v_rcp_f32 v127, v127
    v_pk_mul_f32 v[120:121], v[120:121], v[4:5]
    v_pk_mul_f32 v[122:123], v[122:123], v[6:7]
    v_pk_mul_f32 v[124:125], v[124:125], v[20:21]
    v_pk_mul_f32 v[126:127], v[126:127], v[22:23]
    v_cvt_pk_bf16_f32 v4, v120, v121
    v_cvt_pk_bf16_f32 v5, v122, v123
    v_cvt_pk_bf16_f32 v6, v124, v125
    v_cvt_pk_bf16_f32 v7, v126, v127
    s_add_u32 m0, s96, 94208
    s_add_u32 s53, s95, 81920
    buffer_store_dwordx4 v[4:7], v233, s[36:39], s97 offen offset:1024 sc1
    buffer_load_dwordx4 v218, s[60:63], s53 offen offset:0 lds
    buffer_load_dwordx4 v219, s[60:63], s53 offen offset:1024 lds
    v_pk_mul_f32 v[112:113], v[8:9], v[8:9]
    v_pk_mul_f32 v[114:115], v[10:11], v[10:11]
    v_pk_mul_f32 v[116:117], v[24:25], v[24:25]
    v_pk_mul_f32 v[118:119], v[26:27], v[26:27]
    v_pk_fma_f32 v[112:113], v[112:113], v[196:197], v[196:197] op_sel:[0,0,1] op_sel_hi:[1,0,1]
    v_pk_fma_f32 v[114:115], v[114:115], v[196:197], v[196:197] op_sel:[0,0,1] op_sel_hi:[1,0,1]
    v_pk_fma_f32 v[116:117], v[116:117], v[196:197], v[196:197] op_sel:[0,0,1] op_sel_hi:[1,0,1]
    v_pk_fma_f32 v[118:119], v[118:119], v[196:197], v[196:197] op_sel:[0,0,1] op_sel_hi:[1,0,1]
    v_pk_mul_f32 v[112:113], v[112:113], v[8:9]
    v_pk_mul_f32 v[114:115], v[114:115], v[10:11]
    v_pk_mul_f32 v[116:117], v[116:117], v[24:25]
    v_pk_mul_f32 v[118:119], v[118:119], v[26:27]
    v_exp_f32 v112, v112
    v_exp_f32 v113, v113
    v_exp_f32 v114, v114
    v_exp_f32 v115, v115
    v_exp_f32 v116, v116
    v_exp_f32 v117, v117
    v_exp_f32 v118, v118
    v_exp_f32 v119, v119
    v_pk_fma_f32 v[112:113], v[112:113], v[180:181], v[180:181] op_sel_hi:[1,0,0]
    v_pk_fma_f32 v[114:115], v[114:115], v[180:181], v[180:181] op_sel_hi:[1,0,0]
    v_pk_fma_f32 v[116:117], v[116:117], v[180:181], v[180:181] op_sel_hi:[1,0,0]
    v_pk_fma_f32 v[118:119], v[118:119], v[180:181], v[180:181] op_sel_hi:[1,0,0]
    v_rcp_f32 v112, v112
    v_rcp_f32 v113, v113
    v_rcp_f32 v114, v114
    v_rcp_f32 v115, v115
    v_rcp_f32 v116, v116
    v_rcp_f32 v117, v117
    v_rcp_f32 v118, v118
    v_rcp_f32 v119, v119
    v_pk_mul_f32 v[112:113], v[112:113], v[8:9]
    v_pk_mul_f32 v[114:115], v[114:115], v[10:11]
    v_pk_mul_f32 v[116:117], v[116:117], v[24:25]
    v_pk_mul_f32 v[118:119], v[118:119], v[26:27]
    v_cvt_pk_bf16_f32 v8, v112, v113
    v_cvt_pk_bf16_f32 v9, v114, v115
    v_cvt_pk_bf16_f32 v10, v116, v117
    v_cvt_pk_bf16_f32 v11, v118, v119
    buffer_store_dwordx4 v[8:11], v233, s[36:39], s97 offen offset:2048 sc1
    v_pk_mul_f32 v[120:121], v[12:13], v[12:13]
    v_pk_mul_f32 v[122:123], v[14:15], v[14:15]
    v_pk_mul_f32 v[124:125], v[28:29], v[28:29]
    v_pk_mul_f32 v[126:127], v[30:31], v[30:31]
    v_pk_fma_f32 v[120:121], v[120:121], v[198:199], v[198:199] op_sel:[0,0,1] op_sel_hi:[1,0,1]
    v_pk_fma_f32 v[122:123], v[122:123], v[198:199], v[198:199] op_sel:[0,0,1] op_sel_hi:[1,0,1]
    v_pk_fma_f32 v[124:125], v[124:125], v[198:199], v[198:199] op_sel:[0,0,1] op_sel_hi:[1,0,1]
    v_pk_fma_f32 v[126:127], v[126:127], v[198:199], v[198:199] op_sel:[0,0,1] op_sel_hi:[1,0,1]
    v_pk_mul_f32 v[120:121], v[120:121], v[12:13]
    v_pk_mul_f32 v[122:123], v[122:123], v[14:15]
    v_pk_mul_f32 v[124:125], v[124:125], v[28:29]
    v_pk_mul_f32 v[126:127], v[126:127], v[30:31]
    v_exp_f32 v120, v120
    v_exp_f32 v121, v121
    v_exp_f32 v122, v122
    v_exp_f32 v123, v123
    v_exp_f32 v124, v124
    v_exp_f32 v125, v125
    v_exp_f32 v126, v126
    v_exp_f32 v127, v127
    v_pk_fma_f32 v[120:121], v[120:121], v[182:183], v[182:183] op_sel_hi:[1,0,0]
    v_pk_fma_f32 v[122:123], v[122:123], v[182:183], v[182:183] op_sel_hi:[1,0,0]
    v_pk_fma_f32 v[124:125], v[124:125], v[182:183], v[182:183] op_sel_hi:[1,0,0]
    v_pk_fma_f32 v[126:127], v[126:127], v[182:183], v[182:183] op_sel_hi:[1,0,0]
    v_rcp_f32 v120, v120
    v_rcp_f32 v121, v121
    v_rcp_f32 v122, v122
    v_rcp_f32 v123, v123
    v_rcp_f32 v124, v124
    v_rcp_f32 v125, v125
    v_rcp_f32 v126, v126
    v_rcp_f32 v127, v127
    v_pk_mul_f32 v[120:121], v[120:121], v[12:13]
    v_pk_mul_f32 v[122:123], v[122:123], v[14:15]
    v_pk_mul_f32 v[124:125], v[124:125], v[28:29]
    v_pk_mul_f32 v[126:127], v[126:127], v[30:31]
    v_cvt_pk_bf16_f32 v12, v120, v121
    v_cvt_pk_bf16_f32 v13, v122, v123
    v_cvt_pk_bf16_f32 v14, v124, v125
    v_cvt_pk_bf16_f32 v15, v126, v127
    s_add_u32 m0, s96, 96256
    s_add_u32 s53, s59, 131072
    buffer_store_dwordx4 v[12:15], v233, s[36:39], s97 offen offset:3072 sc1
    buffer_load_dwordx4 v218, s[60:63], s53 offen offset:0 lds
    buffer_load_dwordx4 v219, s[60:63], s53 offen offset:1024 lds
    v_pk_mul_f32 v[112:113], v[96:97], v[96:97]
    v_pk_mul_f32 v[114:115], v[98:99], v[98:99]
    v_pk_mul_f32 v[116:117], v[100:101], v[100:101]
    v_pk_mul_f32 v[118:119], v[102:103], v[102:103]
    v_pk_fma_f32 v[112:113], v[112:113], v[192:193], v[192:193] op_sel:[0,0,1] op_sel_hi:[1,0,1]
    v_pk_fma_f32 v[114:115], v[114:115], v[192:193], v[192:193] op_sel:[0,0,1] op_sel_hi:[1,0,1]
    v_pk_fma_f32 v[116:117], v[116:117], v[194:195], v[194:195] op_sel:[0,0,1] op_sel_hi:[1,0,1]
    v_pk_fma_f32 v[118:119], v[118:119], v[194:195], v[194:195] op_sel:[0,0,1] op_sel_hi:[1,0,1]
    v_pk_mul_f32 v[112:113], v[112:113], v[96:97]
    v_pk_mul_f32 v[114:115], v[114:115], v[98:99]
    v_pk_mul_f32 v[116:117], v[116:117], v[100:101]
    v_pk_mul_f32 v[118:119], v[118:119], v[102:103]
    v_exp_f32 v112, v112
    v_exp_f32 v113, v113
    v_exp_f32 v114, v114
    v_exp_f32 v115, v115
    v_exp_f32 v116, v116
    v_exp_f32 v117, v117
    v_exp_f32 v118, v118
    v_exp_f32 v119, v119
    v_pk_fma_f32 v[112:113], v[112:113], v[176:177], v[176:177] op_sel_hi:[1,0,0]
    v_pk_fma_f32 v[114:115], v[114:115], v[176:177], v[176:177] op_sel_hi:[1,0,0]
    v_pk_fma_f32 v[116:117], v[116:117], v[178:179], v[178:179] op_sel_hi:[1,0,0]
    v_pk_fma_f32 v[118:119], v[118:119], v[178:179], v[178:179] op_sel_hi:[1,0,0]
    v_rcp_f32 v112, v112
    v_rcp_f32 v113, v113
    v_rcp_f32 v114, v114
    v_rcp_f32 v115, v115
    v_rcp_f32 v116, v116
    v_rcp_f32 v117, v117
    v_rcp_f32 v118, v118
    v_rcp_f32 v119, v119
    v_pk_mul_f32 v[112:113], v[112:113], v[96:97]
    v_pk_mul_f32 v[114:115], v[114:115], v[98:99]
    v_pk_mul_f32 v[116:117], v[116:117], v[100:101]
    v_pk_mul_f32 v[118:119], v[118:119], v[102:103]
    v_cvt_pk_bf16_f32 v96, v112, v113
    v_cvt_pk_bf16_f32 v97, v114, v115
    v_cvt_pk_bf16_f32 v98, v116, v117
    v_cvt_pk_bf16_f32 v99, v118, v119
    s_nop 0
    v_permlane16_swap_b32 v96, v98
    v_permlane16_swap_b32 v97, v99
    s_add_u32 m0, s96, 98304
    s_add_u32 s53, s59, 147456
    buffer_store_dwordx4 v[96:99], v160, s[36:39], s99 offen offset:0 sc1
    s_waitcnt lgkmcnt(14)
    buffer_load_dwordx4 v218, s[60:63], s53 offen offset:0 lds
    buffer_load_dwordx4 v219, s[60:63], s53 offen offset:1024 lds
    v_pk_mul_f32 v[120:121], v[104:105], v[104:105]
    v_pk_mul_f32 v[122:123], v[106:107], v[106:107]
    v_pk_mul_f32 v[124:125], v[108:109], v[108:109]
    v_pk_mul_f32 v[126:127], v[110:111], v[110:111]
    v_pk_fma_f32 v[120:121], v[120:121], v[196:197], v[196:197] op_sel:[0,0,1] op_sel_hi:[1,0,1]
    v_pk_fma_f32 v[122:123], v[122:123], v[196:197], v[196:197] op_sel:[0,0,1] op_sel_hi:[1,0,1]
    v_pk_fma_f32 v[124:125], v[124:125], v[198:199], v[198:199] op_sel:[0,0,1] op_sel_hi:[1,0,1]
    v_pk_fma_f32 v[126:127], v[126:127], v[198:199], v[198:199] op_sel:[0,0,1] op_sel_hi:[1,0,1]
    v_pk_mul_f32 v[120:121], v[120:121], v[104:105]
    v_pk_mul_f32 v[122:123], v[122:123], v[106:107]
    v_pk_mul_f32 v[124:125], v[124:125], v[108:109]
    v_pk_mul_f32 v[126:127], v[126:127], v[110:111]
    v_exp_f32 v120, v120
    v_exp_f32 v121, v121
    v_exp_f32 v122, v122
    v_exp_f32 v123, v123
    v_exp_f32 v124, v124
    v_exp_f32 v125, v125
    v_exp_f32 v126, v126
    v_exp_f32 v127, v127
    v_pk_fma_f32 v[120:121], v[120:121], v[180:181], v[180:181] op_sel_hi:[1,0,0]
    v_pk_fma_f32 v[122:123], v[122:123], v[180:181], v[180:181] op_sel_hi:[1,0,0]
    v_pk_fma_f32 v[124:125], v[124:125], v[182:183], v[182:183] op_sel_hi:[1,0,0]
    v_pk_fma_f32 v[126:127], v[126:127], v[182:183], v[182:183] op_sel_hi:[1,0,0]
    v_rcp_f32 v120, v120
    v_rcp_f32 v121, v121
    v_rcp_f32 v122, v122
    v_rcp_f32 v123, v123
    v_rcp_f32 v124, v124
    v_rcp_f32 v125, v125
    v_rcp_f32 v126, v126
    v_rcp_f32 v127, v127
    v_pk_mul_f32 v[120:121], v[120:121], v[104:105]
    v_pk_mul_f32 v[122:123], v[122:123], v[106:107]
    v_pk_mul_f32 v[124:125], v[124:125], v[108:109]
    v_pk_mul_f32 v[126:127], v[126:127], v[110:111]
    v_cvt_pk_bf16_f32 v104, v120, v121
    v_cvt_pk_bf16_f32 v105, v122, v123
    v_cvt_pk_bf16_f32 v106, v124, v125
    v_cvt_pk_bf16_f32 v107, v126, v127
    s_nop 0
    v_permlane16_swap_b32 v104, v106
    v_permlane16_swap_b32 v105, v107
    s_add_u32 m0, s96, 0
    s_add_u32 s53, s81, 131072
    buffer_store_dwordx4 v[104:107], v160, s[36:39], s99 offen offset:2048 sc1
    s_waitcnt lgkmcnt(12)
    buffer_load_dwordx4 v218, s[60:63], s53 offen offset:0 lds
    buffer_load_dwordx4 v219, s[60:63], s53 offen offset:1024 lds
    v_pk_mul_f32 v[112:113], v[32:33], v[32:33]
    v_pk_mul_f32 v[114:115], v[34:35], v[34:35]
    v_pk_mul_f32 v[116:117], v[48:49], v[48:49]
    v_pk_mul_f32 v[118:119], v[50:51], v[50:51]
    v_pk_fma_f32 v[112:113], v[112:113], v[192:193], v[192:193] op_sel:[0,0,1] op_sel_hi:[1,0,1]
    v_pk_fma_f32 v[114:115], v[114:115], v[192:193], v[192:193] op_sel:[0,0,1] op_sel_hi:[1,0,1]
    v_pk_fma_f32 v[116:117], v[116:117], v[192:193], v[192:193] op_sel:[0,0,1] op_sel_hi:[1,0,1]
    v_pk_fma_f32 v[118:119], v[118:119], v[192:193], v[192:193] op_sel:[0,0,1] op_sel_hi:[1,0,1]
    v_pk_mul_f32 v[112:113], v[112:113], v[32:33]
    v_pk_mul_f32 v[114:115], v[114:115], v[34:35]
    v_pk_mul_f32 v[116:117], v[116:117], v[48:49]
    v_pk_mul_f32 v[118:119], v[118:119], v[50:51]
    v_exp_f32 v112, v112
    v_exp_f32 v113, v113
    v_exp_f32 v114, v114
    v_exp_f32 v115, v115
    v_exp_f32 v116, v116
    v_exp_f32 v117, v117
    v_exp_f32 v118, v118
    v_exp_f32_e64 v119, v119
    v_pk_fma_f32 v[112:113], v[112:113], v[176:177], v[176:177] op_sel_hi:[1,0,0]
    v_pk_fma_f32 v[114:115], v[114:115], v[176:177], v[176:177] op_sel_hi:[1,0,0]
    v_pk_fma_f32 v[116:117], v[116:117], v[176:177], v[176:177] op_sel_hi:[1,0,0]
    v_pk_fma_f32 v[118:119], v[118:119], v[176:177], v[176:177] op_sel_hi:[1,0,0]
    v_rcp_f32 v112, v112
    v_rcp_f32 v113, v113
    v_rcp_f32 v114, v114
    v_rcp_f32 v115, v115
    v_rcp_f32 v116, v116
    v_rcp_f32 v117, v117
    v_rcp_f32 v118, v118
    v_rcp_f32 v119, v119
    v_pk_mul_f32 v[112:113], v[112:113], v[32:33]
    v_pk_mul_f32 v[114:115], v[114:115], v[34:35]
    v_pk_mul_f32 v[116:117], v[116:117], v[48:49]
    v_pk_mul_f32 v[118:119], v[118:119], v[50:51]
    v_cvt_pk_bf16_f32 v32, v112, v113
    v_cvt_pk_bf16_f32 v33, v114, v115
    v_cvt_pk_bf16_f32 v34, v116, v117
    v_cvt_pk_bf16_f32 v35, v118, v119
    s_add_u32 m0, s96, 2048
    s_add_u32 s53, s81, 147456
    s_add_u32 s97, s97, 4096
    buffer_store_dwordx4 v[32:35], v233, s[36:39], s97 offen offset:0 sc1
    s_waitcnt lgkmcnt(8)
    buffer_load_dwordx4 v218, s[60:63], s53 offen offset:0 lds
    buffer_load_dwordx4 v219, s[60:63], s53 offen offset:1024 lds
    s_waitcnt vmcnt(33)
    ds_read_b64_tr_b16 a[80:81], v222 offset:6144
    ds_read_b64_tr_b16 a[84:85], v223 offset:6144
    ds_read_b64_tr_b16 a[88:89], v222 offset:6656
    ds_read_b64_tr_b16 a[92:93], v223 offset:6656
    v_pk_mul_f32 v[120:121], v[36:37], v[36:37]
    v_pk_mul_f32 v[122:123], v[38:39], v[38:39]
    v_pk_mul_f32 v[124:125], v[52:53], v[52:53]
    v_pk_mul_f32 v[126:127], v[54:55], v[54:55]
    v_pk_fma_f32 v[120:121], v[120:121], v[194:195], v[194:195] op_sel:[0,0,1] op_sel_hi:[1,0,1]
    v_pk_fma_f32 v[122:123], v[122:123], v[194:195], v[194:195] op_sel:[0,0,1] op_sel_hi:[1,0,1]
    v_pk_fma_f32 v[124:125], v[124:125], v[194:195], v[194:195] op_sel:[0,0,1] op_sel_hi:[1,0,1]
    v_pk_fma_f32 v[126:127], v[126:127], v[194:195], v[194:195] op_sel:[0,0,1] op_sel_hi:[1,0,1]
    v_pk_mul_f32 v[120:121], v[120:121], v[36:37]
    v_pk_mul_f32 v[122:123], v[122:123], v[38:39]
    v_pk_mul_f32 v[124:125], v[124:125], v[52:53]
    v_pk_mul_f32 v[126:127], v[126:127], v[54:55]
    v_exp_f32 v120, v120
    v_exp_f32 v121, v121
    v_exp_f32 v122, v122
    v_exp_f32 v123, v123
    v_exp_f32 v124, v124
    v_exp_f32 v125, v125
    v_exp_f32 v126, v126
    v_exp_f32 v127, v127
    v_pk_fma_f32 v[120:121], v[120:121], v[178:179], v[178:179] op_sel_hi:[1,0,0]
    v_pk_fma_f32 v[122:123], v[122:123], v[178:179], v[178:179] op_sel_hi:[1,0,0]
    v_pk_fma_f32 v[124:125], v[124:125], v[178:179], v[178:179] op_sel_hi:[1,0,0]
    v_pk_fma_f32 v[126:127], v[126:127], v[178:179], v[178:179] op_sel_hi:[1,0,0]
    v_rcp_f32 v120, v120
    v_rcp_f32 v121, v121
    v_rcp_f32 v122, v122
    v_rcp_f32 v123, v123
    v_rcp_f32 v124, v124
    v_rcp_f32 v125, v125
    v_rcp_f32 v126, v126
    v_rcp_f32 v127, v127
    v_pk_mul_f32 v[120:121], v[120:121], v[36:37]
    v_pk_mul_f32 v[122:123], v[122:123], v[38:39]
    v_pk_mul_f32 v[124:125], v[124:125], v[52:53]
    v_pk_mul_f32 v[126:127], v[126:127], v[54:55]
    v_cvt_pk_bf16_f32 v36, v120, v121
    v_cvt_pk_bf16_f32 v37, v122, v123
    v_cvt_pk_bf16_f32 v38, v124, v125
    v_cvt_pk_bf16_f32 v39, v126, v127
    s_add_u32 m0, s96, 4096
    s_add_u32 s53, s94, 131072
    buffer_store_dwordx4 v[36:39], v233, s[36:39], s97 offen offset:1024 sc1
    s_waitcnt lgkmcnt(8)
    buffer_load_dwordx4 v218, s[60:63], s53 offen offset:0 lds
    buffer_load_dwordx4 v219, s[60:63], s53 offen offset:1024 lds
    s_waitcnt vmcnt(34)
    ds_read_b64_tr_b16 a[82:83], v222 offset:8192
    ds_read_b64_tr_b16 a[86:87], v223 offset:8192
    ds_read_b64_tr_b16 a[90:91], v222 offset:8704
    ds_read_b64_tr_b16 a[94:95], v223 offset:8704
    v_pk_mul_f32 v[112:113], v[40:41], v[40:41]
    v_pk_mul_f32 v[114:115], v[42:43], v[42:43]
    v_pk_mul_f32 v[116:117], v[56:57], v[56:57]
    v_pk_mul_f32 v[118:119], v[58:59], v[58:59]
    v_pk_fma_f32 v[112:113], v[112:113], v[196:197], v[196:197] op_sel:[0,0,1] op_sel_hi:[1,0,1]
    v_pk_fma_f32 v[114:115], v[114:115], v[196:197], v[196:197] op_sel:[0,0,1] op_sel_hi:[1,0,1]
    v_pk_fma_f32 v[116:117], v[116:117], v[196:197], v[196:197] op_sel:[0,0,1] op_sel_hi:[1,0,1]
    v_pk_fma_f32 v[118:119], v[118:119], v[196:197], v[196:197] op_sel:[0,0,1] op_sel_hi:[1,0,1]
    v_pk_mul_f32 v[112:113], v[112:113], v[40:41]
    v_pk_mul_f32 v[114:115], v[114:115], v[42:43]
    v_pk_mul_f32 v[116:117], v[116:117], v[56:57]
    v_pk_mul_f32 v[118:119], v[118:119], v[58:59]
    v_exp_f32 v112, v112
    v_exp_f32 v113, v113
    v_exp_f32 v114, v114
    v_exp_f32 v115, v115
    v_exp_f32 v116, v116
    v_exp_f32 v117, v117
    v_exp_f32 v118, v118
    v_exp_f32 v119, v119
    v_pk_fma_f32 v[112:113], v[112:113], v[180:181], v[180:181] op_sel_hi:[1,0,0]
    v_pk_fma_f32 v[114:115], v[114:115], v[180:181], v[180:181] op_sel_hi:[1,0,0]
    v_pk_fma_f32 v[116:117], v[116:117], v[180:181], v[180:181] op_sel_hi:[1,0,0]
    v_pk_fma_f32 v[118:119], v[118:119], v[180:181], v[180:181] op_sel_hi:[1,0,0]
    v_rcp_f32 v112, v112
    v_rcp_f32 v113, v113
    v_rcp_f32 v114, v114
    v_rcp_f32 v115, v115
    v_rcp_f32 v116, v116
    v_rcp_f32 v117, v117
    v_rcp_f32 v118, v118
    v_rcp_f32 v119, v119
    v_pk_mul_f32 v[112:113], v[112:113], v[40:41]
    v_pk_mul_f32 v[114:115], v[114:115], v[42:43]
    v_pk_mul_f32 v[116:117], v[116:117], v[56:57]
    v_pk_mul_f32 v[118:119], v[118:119], v[58:59]
    v_cvt_pk_bf16_f32 v40, v112, v113
    v_cvt_pk_bf16_f32 v41, v114, v115
    v_cvt_pk_bf16_f32 v42, v116, v117
    v_cvt_pk_bf16_f32 v43, v118, v119
    s_add_u32 m0, s96, 6144
    s_add_u32 s53, s94, 147456
    s_waitcnt vmcnt(8)
    buffer_store_dword v240, v248, s[36:39], s98 offen sc1
    buffer_store_dwordx4 v[40:43], v233, s[36:39], s97 offen offset:2048 sc1
    s_waitcnt lgkmcnt(4)
    buffer_load_dwordx4 v218, s[60:63], s53 offen offset:0 lds
    buffer_load_dwordx4 v219, s[60:63], s53 offen offset:1024 lds
    ds_read_b64_tr_b16 a[96:97], v222 offset:45056
    ds_read_b64_tr_b16 a[100:101], v223 offset:45056
    ds_read_b64_tr_b16 a[104:105], v222 offset:45568
    ds_read_b64_tr_b16 a[108:109], v223 offset:45568
    v_pk_mul_f32 v[120:121], v[44:45], v[44:45]
    v_pk_mul_f32 v[122:123], v[46:47], v[46:47]
    v_pk_mul_f32 v[124:125], v[60:61], v[60:61]
    v_pk_mul_f32 v[126:127], v[62:63], v[62:63]
    v_pk_fma_f32 v[120:121], v[120:121], v[198:199], v[198:199] op_sel:[0,0,1] op_sel_hi:[1,0,1]
    v_pk_fma_f32 v[122:123], v[122:123], v[198:199], v[198:199] op_sel:[0,0,1] op_sel_hi:[1,0,1]
    v_pk_fma_f32 v[124:125], v[124:125], v[198:199], v[198:199] op_sel:[0,0,1] op_sel_hi:[1,0,1]
    v_pk_fma_f32 v[126:127], v[126:127], v[198:199], v[198:199] op_sel:[0,0,1] op_sel_hi:[1,0,1]
    v_pk_mul_f32 v[120:121], v[120:121], v[44:45]
    v_pk_mul_f32 v[122:123], v[122:123], v[46:47]
    v_pk_mul_f32 v[124:125], v[124:125], v[60:61]
    v_pk_mul_f32 v[126:127], v[126:127], v[62:63]
    v_exp_f32 v120, v120
    v_exp_f32 v121, v121
    v_exp_f32 v122, v122
    v_exp_f32 v123, v123
    v_exp_f32 v124, v124
    v_exp_f32 v125, v125
    v_exp_f32 v126, v126
    v_exp_f32 v127, v127
    v_pk_fma_f32 v[120:121], v[120:121], v[182:183], v[182:183] op_sel_hi:[1,0,0]
    v_pk_fma_f32 v[122:123], v[122:123], v[182:183], v[182:183] op_sel_hi:[1,0,0]
    v_pk_fma_f32 v[124:125], v[124:125], v[182:183], v[182:183] op_sel_hi:[1,0,0]
    v_pk_fma_f32 v[126:127], v[126:127], v[182:183], v[182:183] op_sel_hi:[1,0,0]
    v_rcp_f32 v120, v120
    v_rcp_f32 v121, v121
    v_rcp_f32 v122, v122
    v_rcp_f32 v123, v123
    v_rcp_f32 v124, v124
    v_rcp_f32 v125, v125
    v_rcp_f32 v126, v126
    v_rcp_f32 v127, v127
    v_pk_mul_f32 v[120:121], v[120:121], v[44:45]
    v_pk_mul_f32 v[122:123], v[122:123], v[46:47]
    v_pk_mul_f32 v[124:125], v[124:125], v[60:61]
    v_pk_mul_f32 v[126:127], v[126:127], v[62:63]
    v_cvt_pk_bf16_f32 v44, v120, v121
    v_cvt_pk_bf16_f32 v45, v122, v123
    v_cvt_pk_bf16_f32 v46, v124, v125
    v_cvt_pk_bf16_f32 v47, v126, v127
    s_add_u32 m0, s96, 8192
    s_add_u32 s53, s95, 131072
    buffer_store_dwordx4 v[44:47], v233, s[36:39], s97 offen offset:3072 sc1
    s_waitcnt lgkmcnt(4)
    buffer_load_dwordx4 v218, s[60:63], s53 offen offset:0 lds
    buffer_load_dwordx4 v219, s[60:63], s53 offen offset:1024 lds
    ds_read_b64_tr_b16 a[98:99], v222 offset:47104
    ds_read_b64_tr_b16 a[102:103], v223 offset:47104
    ds_read_b64_tr_b16 a[106:107], v222 offset:47616
    ds_read_b64_tr_b16 a[110:111], v223 offset:47616
    v_pk_mul_f32 v[112:113], v[64:65], v[64:65]
    v_pk_mul_f32 v[114:115], v[66:67], v[66:67]
    v_pk_mul_f32 v[116:117], v[80:81], v[80:81]
    v_pk_mul_f32 v[118:119], v[82:83], v[82:83]
    v_pk_fma_f32 v[112:113], v[112:113], v[192:193], v[192:193] op_sel:[0,0,1] op_sel_hi:[1,0,1]
    v_pk_fma_f32 v[114:115], v[114:115], v[192:193], v[192:193] op_sel:[0,0,1] op_sel_hi:[1,0,1]
    v_pk_fma_f32 v[116:117], v[116:117], v[192:193], v[192:193] op_sel:[0,0,1] op_sel_hi:[1,0,1]
    v_pk_fma_f32 v[118:119], v[118:119], v[192:193], v[192:193] op_sel:[0,0,1] op_sel_hi:[1,0,1]
    v_pk_mul_f32 v[112:113], v[112:113], v[64:65]
    v_pk_mul_f32 v[114:115], v[114:115], v[66:67]
    v_pk_mul_f32 v[116:117], v[116:117], v[80:81]
    v_pk_mul_f32 v[118:119], v[118:119], v[82:83]
    v_exp_f32 v112, v112
    v_exp_f32 v113, v113
    v_exp_f32 v114, v114
    v_exp_f32 v115, v115
    v_exp_f32 v116, v116
    v_exp_f32 v117, v117
    v_exp_f32 v118, v118
    v_exp_f32_e64 v119, v119
    v_pk_fma_f32 v[112:113], v[112:113], v[176:177], v[176:177] op_sel_hi:[1,0,0]
    v_pk_fma_f32 v[114:115], v[114:115], v[176:177], v[176:177] op_sel_hi:[1,0,0]
    v_pk_fma_f32 v[116:117], v[116:117], v[176:177], v[176:177] op_sel_hi:[1,0,0]
    v_pk_fma_f32 v[118:119], v[118:119], v[176:177], v[176:177] op_sel_hi:[1,0,0]
    v_rcp_f32 v112, v112
    v_rcp_f32 v113, v113
    v_rcp_f32 v114, v114
    v_rcp_f32 v115, v115
    v_rcp_f32 v116, v116
    v_rcp_f32 v117, v117
    v_rcp_f32 v118, v118
    v_rcp_f32 v119, v119
    v_pk_mul_f32 v[112:113], v[112:113], v[64:65]
    v_pk_mul_f32 v[114:115], v[114:115], v[66:67]
    v_pk_mul_f32 v[116:117], v[116:117], v[80:81]
    v_pk_mul_f32 v[118:119], v[118:119], v[82:83]
    v_cvt_pk_bf16_f32 v64, v112, v113
    v_cvt_pk_bf16_f32 v65, v114, v115
    v_cvt_pk_bf16_f32 v66, v116, v117
    v_cvt_pk_bf16_f32 v67, v118, v119
    s_add_u32 m0, s96, 45056
    s_add_u32 s53, s95, 147456
    s_add_u32 s97, s97, 4096
    buffer_store_dwordx4 v[64:67], v233, s[36:39], s97 offen offset:0 sc1
    s_waitcnt lgkmcnt(4)
    buffer_load_dwordx4 v218, s[60:63], s53 offen offset:0 lds
    buffer_load_dwordx4 v219, s[60:63], s53 offen offset:1024 lds
    ds_read_b64_tr_b16 a[112:113], v222 offset:49152
    ds_read_b64_tr_b16 a[116:117], v223 offset:49152
    ds_read_b64_tr_b16 a[120:121], v222 offset:49664
    ds_read_b64_tr_b16 a[124:125], v223 offset:49664
    v_pk_mul_f32 v[120:121], v[68:69], v[68:69]
    v_pk_mul_f32 v[122:123], v[70:71], v[70:71]
    v_pk_mul_f32 v[124:125], v[84:85], v[84:85]
    v_pk_mul_f32 v[126:127], v[86:87], v[86:87]
    v_pk_fma_f32 v[120:121], v[120:121], v[194:195], v[194:195] op_sel:[0,0,1] op_sel_hi:[1,0,1]
    v_pk_fma_f32 v[122:123], v[122:123], v[194:195], v[194:195] op_sel:[0,0,1] op_sel_hi:[1,0,1]
    v_pk_fma_f32 v[124:125], v[124:125], v[194:195], v[194:195] op_sel:[0,0,1] op_sel_hi:[1,0,1]
    v_pk_fma_f32 v[126:127], v[126:127], v[194:195], v[194:195] op_sel:[0,0,1] op_sel_hi:[1,0,1]
    v_pk_mul_f32 v[120:121], v[120:121], v[68:69]
    v_pk_mul_f32 v[122:123], v[122:123], v[70:71]
    v_pk_mul_f32 v[124:125], v[124:125], v[84:85]
    v_pk_mul_f32 v[126:127], v[126:127], v[86:87]
    v_exp_f32 v120, v120
    v_exp_f32 v121, v121
    v_exp_f32 v122, v122
    v_exp_f32 v123, v123
    v_exp_f32 v124, v124
    v_exp_f32 v125, v125
    v_exp_f32 v126, v126
    v_exp_f32_e64 v127, v127
    v_pk_fma_f32 v[120:121], v[120:121], v[178:179], v[178:179] op_sel_hi:[1,0,0]
    v_pk_fma_f32 v[122:123], v[122:123], v[178:179], v[178:179] op_sel_hi:[1,0,0]
    v_pk_fma_f32 v[124:125], v[124:125], v[178:179], v[178:179] op_sel_hi:[1,0,0]
    v_pk_fma_f32 v[126:127], v[126:127], v[178:179], v[178:179] op_sel_hi:[1,0,0]
    v_rcp_f32 v120, v120
    v_rcp_f32 v121, v121
    v_rcp_f32 v122, v122
    v_rcp_f32 v123, v123
    v_rcp_f32 v124, v124
    v_rcp_f32 v125, v125
    v_rcp_f32 v126, v126
    v_rcp_f32 v127, v127
    v_pk_mul_f32 v[120:121], v[120:121], v[68:69]
    v_pk_mul_f32 v[122:123], v[122:123], v[70:71]
    v_pk_mul_f32 v[124:125], v[124:125], v[84:85]
    v_pk_mul_f32 v[126:127], v[126:127], v[86:87]
    v_cvt_pk_bf16_f32 v68, v120, v121
    v_cvt_pk_bf16_f32 v69, v122, v123
    v_cvt_pk_bf16_f32 v70, v124, v125
    v_cvt_pk_bf16_f32 v71, v126, v127
    s_add_u32 m0, s96, 47104
    s_xor_b32 s53, s57, 0
    buffer_store_dwordx4 v[68:71], v233, s[36:39], s97 offen offset:1024 sc1
    s_waitcnt lgkmcnt(4)
    buffer_load_dwordx4 v220, s[64:67], s53 offen offset:0 lds
    buffer_load_dwordx4 v221, s[64:67], s53 offen offset:1024 lds
    ds_read_b64_tr_b16 a[114:115], v222 offset:51200
    ds_read_b64_tr_b16 a[118:119], v223 offset:51200
    ds_read_b64_tr_b16 a[122:123], v222 offset:51712
    ds_read_b64_tr_b16 a[126:127], v223 offset:51712
    v_pk_mul_f32 v[112:113], v[72:73], v[72:73]
    v_pk_mul_f32 v[114:115], v[74:75], v[74:75]
    v_pk_mul_f32 v[116:117], v[88:89], v[88:89]
    v_pk_mul_f32 v[118:119], v[90:91], v[90:91]
    v_pk_fma_f32 v[112:113], v[112:113], v[196:197], v[196:197] op_sel:[0,0,1] op_sel_hi:[1,0,1]
    v_pk_fma_f32 v[114:115], v[114:115], v[196:197], v[196:197] op_sel:[0,0,1] op_sel_hi:[1,0,1]
    v_pk_fma_f32 v[116:117], v[116:117], v[196:197], v[196:197] op_sel:[0,0,1] op_sel_hi:[1,0,1]
    v_pk_fma_f32 v[118:119], v[118:119], v[196:197], v[196:197] op_sel:[0,0,1] op_sel_hi:[1,0,1]
    v_pk_mul_f32 v[112:113], v[112:113], v[72:73]
    v_pk_mul_f32 v[114:115], v[114:115], v[74:75]
    v_pk_mul_f32 v[116:117], v[116:117], v[88:89]
    v_pk_mul_f32 v[118:119], v[118:119], v[90:91]
    v_exp_f32 v112, v112
    v_exp_f32 v113, v113
    v_exp_f32 v114, v114
    v_exp_f32 v115, v115
    v_exp_f32 v116, v116
    v_exp_f32 v117, v117
    v_exp_f32 v118, v118
    v_exp_f32 v119, v119
    v_pk_fma_f32 v[112:113], v[112:113], v[180:181], v[180:181] op_sel_hi:[1,0,0]
    v_pk_fma_f32 v[114:115], v[114:115], v[180:181], v[180:181] op_sel_hi:[1,0,0]
    v_pk_fma_f32 v[116:117], v[116:117], v[180:181], v[180:181] op_sel_hi:[1,0,0]
    v_pk_fma_f32 v[118:119], v[118:119], v[180:181], v[180:181] op_sel_hi:[1,0,0]
    v_rcp_f32 v112, v112
    v_rcp_f32 v113, v113
    v_rcp_f32 v114, v114
    v_rcp_f32 v115, v115
    v_rcp_f32 v116, v116
    v_rcp_f32 v117, v117
    v_rcp_f32 v118, v118
    v_rcp_f32 v119, v119
    v_pk_mul_f32 v[112:113], v[112:113], v[72:73]
    v_pk_mul_f32 v[114:115], v[114:115], v[74:75]
    v_pk_mul_f32 v[116:117], v[116:117], v[88:89]
    v_pk_mul_f32 v[118:119], v[118:119], v[90:91]
    v_cvt_pk_bf16_f32 v72, v112, v113
    v_cvt_pk_bf16_f32 v73, v114, v115
    v_cvt_pk_bf16_f32 v74, v116, v117
    v_cvt_pk_bf16_f32 v75, v118, v119
    s_add_u32 m0, s96, 49152
    s_xor_b32 s53, s57, 4096
    buffer_store_dwordx4 v[72:75], v233, s[36:39], s97 offen offset:2048 sc1
    s_waitcnt lgkmcnt(4)
    buffer_load_dwordx4 v220, s[64:67], s53 offen offset:0 lds
    buffer_load_dwordx4 v221, s[64:67], s53 offen offset:1024 lds
    ds_read_b64_tr_b16 a[128:129], v222 offset:53248
    ds_read_b64_tr_b16 a[132:133], v223 offset:53248
    ds_read_b64_tr_b16 a[136:137], v222 offset:53760
    ds_read_b64_tr_b16 a[140:141], v223 offset:53760
    v_pk_mul_f32 v[120:121], v[76:77], v[76:77]
    v_pk_mul_f32 v[122:123], v[78:79], v[78:79]
    v_pk_mul_f32 v[124:125], v[92:93], v[92:93]
    v_pk_mul_f32 v[126:127], v[94:95], v[94:95]
    v_pk_fma_f32 v[120:121], v[120:121], v[198:199], v[198:199] op_sel:[0,0,1] op_sel_hi:[1,0,1]
    v_pk_fma_f32 v[122:123], v[122:123], v[198:199], v[198:199] op_sel:[0,0,1] op_sel_hi:[1,0,1]
    v_pk_fma_f32 v[124:125], v[124:125], v[198:199], v[198:199] op_sel:[0,0,1] op_sel_hi:[1,0,1]
    v_pk_fma_f32 v[126:127], v[126:127], v[198:199], v[198:199] op_sel:[0,0,1] op_sel_hi:[1,0,1]
    v_pk_mul_f32 v[120:121], v[120:121], v[76:77]
    v_pk_mul_f32 v[122:123], v[122:123], v[78:79]
    v_pk_mul_f32 v[124:125], v[124:125], v[92:93]
    v_pk_mul_f32 v[126:127], v[126:127], v[94:95]
    v_exp_f32 v120, v120
    v_exp_f32 v121, v121
    v_exp_f32 v122, v122
    v_exp_f32 v123, v123
    v_exp_f32 v124, v124
    v_exp_f32 v125, v125
    v_exp_f32 v126, v126
    v_exp_f32_e64 v127, v127
    v_pk_fma_f32 v[120:121], v[120:121], v[182:183], v[182:183] op_sel_hi:[1,0,0]
    v_pk_fma_f32 v[122:123], v[122:123], v[182:183], v[182:183] op_sel_hi:[1,0,0]
    v_pk_fma_f32 v[124:125], v[124:125], v[182:183], v[182:183] op_sel_hi:[1,0,0]
    v_pk_fma_f32 v[126:127], v[126:127], v[182:183], v[182:183] op_sel_hi:[1,0,0]
    v_rcp_f32 v120, v120
    v_rcp_f32 v121, v121
    v_rcp_f32 v122, v122
    v_rcp_f32 v123, v123
    v_rcp_f32 v124, v124
    v_rcp_f32 v125, v125
    v_rcp_f32 v126, v126
    v_rcp_f32 v127, v127
    v_pk_mul_f32 v[120:121], v[120:121], v[76:77]
    v_pk_mul_f32 v[122:123], v[122:123], v[78:79]
    v_pk_mul_f32 v[124:125], v[124:125], v[92:93]
    v_pk_mul_f32 v[126:127], v[126:127], v[94:95]
    v_cvt_pk_bf16_f32 v76, v120, v121
    v_cvt_pk_bf16_f32 v77, v122, v123
    v_cvt_pk_bf16_f32 v78, v124, v125
    v_cvt_pk_bf16_f32 v79, v126, v127
    s_add_u32 m0, s96, 51200
    s_xor_b32 s53, s57, 32768
    buffer_store_dwordx4 v[76:79], v233, s[36:39], s97 offen offset:3072 sc1
    buffer_load_dword v246, v251, s[36:39], s42 offen sc1
    s_waitcnt lgkmcnt(4)
    buffer_load_dwordx4 v220, s[64:67], s53 offen offset:0 lds
    buffer_load_dwordx4 v221, s[64:67], s53 offen offset:1024 lds
    ds_read_b64_tr_b16 a[130:131], v224 offset:0
    ds_read_b64_tr_b16 a[134:135], v225 offset:0
    ds_read_b64_tr_b16 a[138:139], v224 offset:512
    ds_read_b64_tr_b16 a[142:143], v225 offset:512
    s_add_u32 s98, s98, 0x20000
    s_add_u32 m0, s96, 53248
    s_xor_b32 s53, s57, 36864
    s_waitcnt lgkmcnt(0)
    buffer_load_dwordx4 v220, s[64:67], s53 offen offset:0 lds
    buffer_load_dwordx4 v221, s[64:67], s53 offen offset:1024 lds
    s_add_u32 m0, s96, 90112
    s_xor_b32 s53, s57, 65536
    buffer_load_dwordx4 v220, s[64:67], s53 offen offset:0 lds
    buffer_load_dwordx4 v221, s[64:67], s53 offen offset:1024 lds
    ds_read_b64_tr_b16 a[144:145], v224 offset:2048
    ds_read_b64_tr_b16 a[148:149], v225 offset:2048
    ds_read_b64_tr_b16 a[152:153], v224 offset:2560
    ds_read_b64_tr_b16 a[156:157], v225 offset:2560
    ds_read_b64_tr_b16 a[146:147], v224 offset:4096
    ds_read_b64_tr_b16 a[150:151], v225 offset:4096
    ds_read_b64_tr_b16 a[154:155], v224 offset:4608
    ds_read_b64_tr_b16 a[158:159], v225 offset:4608
    ds_read_b64_tr_b16 a[160:161], v224 offset:6144
    ds_read_b64_tr_b16 a[164:165], v225 offset:6144
    ds_read_b64_tr_b16 a[168:169], v224 offset:6656
    ds_read_b64_tr_b16 a[172:173], v225 offset:6656
    s_waitcnt vmcnt(7)
    buffer_store_dword v240, v248, s[36:39], s98 offen sc1
    s_add_u32 m0, s96, 92160
    ds_read_b64_tr_b16 a[162:163], v224 offset:8192
    s_xor_b32 s53, s57, 69632
    ds_read_b64_tr_b16 a[166:167], v225 offset:8192
    s_waitcnt lgkmcnt(6)
    buffer_load_dwordx4 v220, s[64:67], s53 offen offset:0 lds
    ds_read_b64_tr_b16 a[170:171], v224 offset:8704
    buffer_load_dwordx4 v221, s[64:67], s53 offen offset:1024 lds
    ds_read_b64_tr_b16 a[174:175], v225 offset:8704
    s_add_u32 m0, s96, 94208
    s_xor_b32 s53, s57, 98304
    buffer_load_dwordx4 v220, s[64:67], s53 offen offset:0 lds
    buffer_load_dwordx4 v221, s[64:67], s53 offen offset:1024 lds
    s_add_u32 m0, s96, 96256
    s_xor_b32 s53, s57, 102400
    s_waitcnt lgkmcnt(4)
    buffer_load_dwordx4 v220, s[64:67], s53 offen offset:0 lds
    buffer_load_dwordx4 v221, s[64:67], s53 offen offset:1024 lds
    s_mov_b32 m0, s58
    s_nop 0
    buffer_load_dword v228, s[76:79], s49 offen offset:2048 lds
    buffer_load_dwordx4 v247, s[68:71], s43 offen offset:0 lds
    buffer_load_dwordx4 v249, s[68:71], s43 offen offset:1024 lds
    s_waitcnt vmcnt(16)
    v_cmp_le_u32 vcc, 1, v246
    s_nop 1
    s_cmp_eq_u64 vcc, -1
    s_cbranch_scc0 L_ffpe_spin
L_ffpe_ok:
    s_add_u32 s42, s42, 0x20000
    buffer_load_dwordx4 a[176:179], v232, s[36:39], s0 offen sc1
    buffer_load_dwordx4 a[180:183], v232, s[36:39], s1 offen sc1
    buffer_load_dwordx4 a[184:187], v231, s[36:39], s0 offen sc1
    buffer_load_dwordx4 a[188:191], v231, s[36:39], s1 offen sc1
    buffer_load_dwordx4 a[192:195], v230, s[36:39], s0 offen sc1
    buffer_load_dwordx4 a[196:199], v230, s[36:39], s1 offen sc1
    buffer_load_dwordx4 a[200:203], v229, s[36:39], s0 offen sc1
    buffer_load_dwordx4 a[204:207], v229, s[36:39], s1 offen sc1
    buffer_load_dwordx4 a[208:211], v232, s[36:39], s10 offen sc1
    buffer_load_dwordx4 a[212:215], v232, s[36:39], s11 offen sc1
    buffer_load_dwordx4 a[216:219], v231, s[36:39], s10 offen sc1
    buffer_load_dwordx4 a[220:223], v231, s[36:39], s11 offen sc1
    s_branch R_p2
.p2alignl 12, 0xbf810000
.fill 512, 4, 0xbf810000
R_p2:
L_p2:
    v_lshrrev_b32 v180, 4, v255
    v_lshlrev_b32 v180, 3, v180
    v_add_u32 v178, s58, v180
    v_and_b32_e64 v181, 15, v255
    s_waitcnt vmcnt(12)
    ds_read_b64 v[152:153], v178 offset:2048
    ds_read_b64 v[154:155], v178 offset:2080
    ds_read_b64 v[156:157], v178 offset:2112
    ds_read_b64 v[158:159], v178 offset:2144
    v_mad_u32_u24 v176, v181, 9, 0
    v_lshl_add_u32 v176, v176, 4, v178
    v_lshl_add_u32 v178, v181, 7, v178
    s_waitcnt vmcnt(10)
    v_mfma_f32_16x16x32_bf16 v[112:115], a[0:3], a[176:179], 0
    s_waitcnt lgkmcnt(3)
    v_lshlrev_b32_e64 v64, 16, v152
    v_mfma_f32_16x16x32_bf16 v[112:115], a[16:19], a[180:183], v[112:115]
    buffer_load_dwordx4 a[224:227], v230, s[36:39], s10 offen sc1
    v_and_b32 v65, 0xffff0000, v152
    v_mfma_f32_16x16x32_bf16 v[116:119], a[20:23], a[180:183], 0
    v_lshlrev_b32_e64 v66, 16, v153
    v_mfma_f32_16x16x32_bf16 v[116:119], a[4:7], a[176:179], v[116:119]
    v_and_b32 v67, 0xffff0000, v153
    v_mfma_f32_16x16x32_bf16 v[120:123], a[8:11], a[176:179], 0
    s_waitcnt lgkmcnt(2)
    v_lshlrev_b32 v68, 16, v154
    v_mfma_f32_16x16x32_bf16 v[120:123], a[24:27], a[180:183], v[120:123]
    v_and_b32 v69, 0xffff0000, v154
    v_mfma_f32_16x16x32_bf16 v[124:127], a[28:31], a[180:183], 0
    buffer_load_dwordx4 a[228:231], v230, s[36:39], s11 offen sc1
    v_mfma_f32_16x16x32_bf16 v[124:127], a[12:15], a[176:179], v[124:127]
    s_waitcnt vmcnt(10)
    v_lshlrev_b32 v70, 16, v155
    v_and_b32 v71, 0xffff0000, v155
    v_mfma_f32_16x16x32_bf16 v[96:99], a[0:3], a[184:187], 0
    s_waitcnt lgkmcnt(1)
    v_lshlrev_b32 v72, 16, v156
    v_mfma_f32_16x16x32_bf16 v[96:99], a[16:19], a[188:191], v[96:99]
    buffer_load_dword v246, v251, s[36:39], s42 offen sc1
    v_and_b32 v73, 0xffff0000, v156
    v_mfma_f32_16x16x32_bf16 v[100:103], a[20:23], a[188:191], 0
    buffer_load_dwordx4 a[232:235], v229, s[36:39], s10 offen sc1
    v_mfma_f32_16x16x32_bf16 v[100:103], a[4:7], a[184:187], v[100:103]
    v_lshlrev_b32 v74, 16, v157
    v_mfma_f32_16x16x32_bf16 v[104:107], a[8:11], a[184:187], 0
    s_waitcnt lgkmcnt(0)
    v_and_b32 v75, 0xffff0000, v157
    v_lshlrev_b32_e64 v76, 16, v158
    v_mfma_f32_16x16x32_bf16 v[104:107], a[24:27], a[188:191], v[104:107]
    v_and_b32 v77, 0xffff0000, v158
    v_mfma_f32_16x16x32_bf16 v[108:111], a[28:31], a[188:191], 0
    buffer_load_dwordx4 a[236:239], v229, s[36:39], s11 offen sc1
    v_mfma_f32_16x16x32_bf16 v[108:111], a[12:15], a[184:187], v[108:111]
    s_waitcnt vmcnt(11)
    v_lshlrev_b32 v78, 16, v159
    v_and_b32 v79, 0xffff0000, v159
    v_mfma_f32_16x16x32_bf16 v[80:83], a[0:3], a[192:195], 0
    ds_read_b64 v[144:145], v178 offset:0
    v_mfma_f32_16x16x32_bf16 v[80:83], a[16:19], a[196:199], v[80:83]
    ds_read_b64 v[146:147], v178 offset:32
    v_mfma_f32_16x16x32_bf16 v[84:87], a[20:23], a[196:199], 0
    buffer_load_dwordx4 a[176:179], v232, s[36:39], s41 offen sc1
    v_mfma_f32_16x16x32_bf16 v[84:87], a[4:7], a[192:195], v[84:87]
    ds_read_b64 v[148:149], v178 offset:64
    v_mfma_f32_16x16x32_bf16 v[88:91], a[8:11], a[192:195], 0
    ds_read_b64 v[150:151], v178 offset:96
    v_mfma_f32_16x16x32_bf16 v[88:91], a[24:27], a[196:199], v[88:91]
    s_xor_b32 s53, s41, 4096
    v_subrev_u32 v208, s96, v222
    v_mfma_f32_16x16x32_bf16 v[92:95], a[28:31], a[196:199], 0
    buffer_load_dwordx4 a[180:183], v232, s[36:39], s53 offen sc1
    v_mfma_f32_16x16x32_bf16 v[92:95], a[12:15], a[192:195], v[92:95]
    s_add_u32 s90, s40, 32768
    v_subrev_u32 v209, s96, v223
    s_waitcnt vmcnt(11)
    v_mfma_f32_16x16x32_bf16 v[64:67], a[0:3], a[200:203], v[64:67]
    v_lshrrev_b32 v177, 3, v255
    v_mfma_f32_16x16x32_bf16 v[64:67], a[16:19], a[204:207], v[64:67]
    buffer_load_dwordx4 a[184:187], v231, s[36:39], s41 offen sc1
    v_mul_u32_u24 v177, 144, v177
    v_mfma_f32_16x16x32_bf16 v[68:71], a[20:23], a[204:207], v[68:71]
    v_and_b32 v180, 0x70, v254
    v_mfma_f32_16x16x32_bf16 v[68:71], a[4:7], a[200:203], v[68:71]
    v_add3_u32 v177, v177, v180, s58
    v_mfma_f32_16x16x32_bf16 v[72:75], a[8:11], a[200:203], v[72:75]
    v_add_u32 v210, 45056, v208
    v_mfma_f32_16x16x32_bf16 v[72:75], a[24:27], a[204:207], v[72:75]
    v_add_u32 v211, 45056, v209
    v_mfma_f32_16x16x32_bf16 v[76:79], a[28:31], a[204:207], v[76:79]
    buffer_load_dwordx4 a[188:191], v231, s[36:39], s53 offen sc1
    v_mfma_f32_16x16x32_bf16 v[76:79], a[12:15], a[200:203], v[76:79]
    v_add_u32 v212, 90112, v208
    v_add_u32 v213, 90112, v209
    s_barrier
    s_waitcnt vmcnt(11)
    v_mfma_f32_16x16x32_bf16 v[112:115], a[32:35], a[208:211], v[112:115]
    ds_read_b64_tr_b16 a[0:1], v222 offset:0
    v_mfma_f32_16x16x32_bf16 v[112:115], a[48:51], a[212:215], v[112:115]
    ds_read_b64_tr_b16 a[4:5], v223 offset:0
    ds_read_b64_tr_b16 a[8:9], v222 offset:512
    v_mfma_f32_16x16x32_bf16 v[116:119], a[52:55], a[212:215], v[116:119]
    buffer_load_dwordx4 a[192:195], v230, s[36:39], s41 offen sc1
    v_mfma_f32_16x16x32_bf16 v[116:119], a[36:39], a[208:211], v[116:119]
    ds_read_b64_tr_b16 a[12:13], v223 offset:512
    ds_read_b64_tr_b16 v[192:193], v210 offset:2048
    v_mfma_f32_16x16x32_bf16 v[120:123], a[40:43], a[208:211], v[120:123]
    ds_read_b64_tr_b16 v[196:197], v211 offset:2048
    ds_read_b64_tr_b16 v[200:201], v210 offset:2560
    v_mfma_f32_16x16x32_bf16 v[120:123], a[56:59], a[212:215], v[120:123]
    ds_read_b64_tr_b16 v[204:205], v211 offset:2560
    buffer_load_dwordx4 a[196:199], v230, s[36:39], s53 offen sc1
    v_mfma_f32_16x16x32_bf16 v[124:127], a[60:63], a[212:215], v[124:127]
    ds_read_b64_tr_b16 v[194:195], v210 offset:4096
    v_mfma_f32_16x16x32_bf16 v[124:127], a[44:47], a[208:211], v[124:127]
    s_waitcnt lgkmcnt(12)
    v_lshlrev_b32 v160, 16, v144
    v_and_b32 v161, 0xffff0000, v144
    s_waitcnt vmcnt(11)
    v_mfma_f32_16x16x32_bf16 v[96:99], a[32:35], a[216:219], v[96:99]
    ds_read_b64_tr_b16 a[2:3], v222 offset:2048
    v_mfma_f32_16x16x32_bf16 v[96:99], a[48:51], a[220:223], v[96:99]
    ds_read_b64_tr_b16 a[6:7], v223 offset:2048
    ds_read_b64_tr_b16 a[10:11], v222 offset:2560
    v_mfma_f32_16x16x32_bf16 v[100:103], a[52:55], a[220:223], v[100:103]
    buffer_load_dwordx4 a[200:203], v229, s[36:39], s41 offen sc1
    v_mfma_f32_16x16x32_bf16 v[100:103], a[36:39], a[216:219], v[100:103]
    ds_read_b64_tr_b16 a[14:15], v223 offset:2560
    ds_read_b64_tr_b16 v[198:199], v211 offset:4096
    v_mfma_f32_16x16x32_bf16 v[104:107], a[40:43], a[216:219], v[104:107]
    ds_read_b64_tr_b16 v[202:203], v210 offset:4608
    ds_read_b64_tr_b16 v[206:207], v211 offset:4608
    v_mfma_f32_16x16x32_bf16 v[104:107], a[56:59], a[220:223], v[104:107]
    ds_read_b64_tr_b16 v[16:17], v210 offset:6144
    buffer_load_dwordx4 a[204:207], v229, s[36:39], s53 offen sc1
    v_mfma_f32_16x16x32_bf16 v[108:111], a[60:63], a[220:223], v[108:111]
    ds_read_b64_tr_b16 v[20:21], v211 offset:6144
    v_mfma_f32_16x16x32_bf16 v[108:111], a[44:47], a[216:219], v[108:111]
    s_waitcnt vmcnt(11)
    v_lshlrev_b32_e64 v162, 16, v145
    v_and_b32 v163, 0xffff0000, v145
    v_mfma_f32_16x16x32_bf16 v[80:83], a[32:35], a[224:227], v[80:83]
    ds_read_b64_tr_b16 a[16:17], v222 offset:4096
    ds_read_b64_tr_b16 a[20:21], v223 offset:4096
    v_mfma_f32_16x16x32_bf16 v[80:83], a[48:51], a[228:231], v[80:83]
    ds_read_b64_tr_b16 a[24:25], v222 offset:4608
    s_waitcnt vmcnt(10)
    v_cmp_le_u32 vcc, 1, v246
    s_nop 1
    s_cmp_eq_u64 vcc, -1
    s_cbranch_scc0 L_py_spin
L_py_ok:
    s_add_u32 s3, s0, 4096
    buffer_load_dwordx4 a[208:211], v232, s[36:39], s3 offen sc1
    v_mfma_f32_16x16x32_bf16 v[84:87], a[52:55], a[228:231], v[84:87]
    ds_read_b64_tr_b16 a[28:29], v223 offset:4608
    v_mfma_f32_16x16x32_bf16 v[84:87], a[36:39], a[224:227], v[84:87]
    ds_read_b64_tr_b16 v[24:25], v210 offset:6656
    v_mfma_f32_16x16x32_bf16 v[88:91], a[40:43], a[224:227], v[88:91]
    ds_read_b64_tr_b16 v[28:29], v211 offset:6656
    v_mfma_f32_16x16x32_bf16 v[88:91], a[56:59], a[228:231], v[88:91]
    ds_read_b64_tr_b16 v[18:19], v210 offset:8192
    ds_read_b64_tr_b16 v[22:23], v211 offset:8192
    v_mfma_f32_16x16x32_bf16 v[92:95], a[60:63], a[228:231], v[92:95]
    s_add_u32 s53, s1, 4096
    buffer_load_dwordx4 a[212:215], v232, s[36:39], s53 offen sc1
    v_mfma_f32_16x16x32_bf16 v[92:95], a[44:47], a[224:227], v[92:95]
    ds_read_b64_tr_b16 v[26:27], v210 offset:8704
    s_waitcnt lgkmcnt(14)
    v_lshlrev_b32 v164, 16, v146
    v_and_b32 v165, 0xffff0000, v146
    s_waitcnt vmcnt(10)
    v_mfma_f32_16x16x32_bf16 v[64:67], a[32:35], a[232:235], v[64:67]
    ds_read_b64_tr_b16 a[18:19], v222 offset:6144
    v_mfma_f32_16x16x32_bf16 v[64:67], a[48:51], a[236:239], v[64:67]
    ds_read_b64_tr_b16 a[22:23], v223 offset:6144
    ds_read_b64_tr_b16 a[26:27], v222 offset:6656
    v_mfma_f32_16x16x32_bf16 v[68:71], a[52:55], a[236:239], v[68:71]
    buffer_load_dwordx4 a[216:219], v231, s[36:39], s3 offen sc1
    v_mfma_f32_16x16x32_bf16 v[68:71], a[36:39], a[232:235], v[68:71]
    ds_read_b64_tr_b16 a[30:31], v223 offset:6656
    ds_read_b64_tr_b16 v[30:31], v211 offset:8704
    v_mfma_f32_16x16x32_bf16 v[72:75], a[40:43], a[232:235], v[72:75]
    ds_read_b64_tr_b16 v[32:33], v212 offset:0
    ds_read_b64_tr_b16 v[36:37], v213 offset:0
    v_mfma_f32_16x16x32_bf16 v[72:75], a[56:59], a[236:239], v[72:75]
    ds_read_b64_tr_b16 v[40:41], v212 offset:512
    buffer_load_dwordx4 a[220:223], v231, s[36:39], s53 offen sc1
    v_mfma_f32_16x16x32_bf16 v[76:79], a[60:63], a[236:239], v[76:79]
    ds_read_b64_tr_b16 v[44:45], v213 offset:512
    v_mfma_f32_16x16x32_bf16 v[76:79], a[44:47], a[232:235], v[76:79]
    s_waitcnt vmcnt(10)
    v_lshlrev_b32 v166, 16, v147
    v_and_b32 v167, 0xffff0000, v147
    v_mfma_f32_16x16x32_bf16 v[112:115], a[64:67], a[176:179], v[112:115]
    ds_read_b64_tr_b16 a[32:33], v222 offset:8192
    v_mfma_f32_16x16x32_bf16 v[112:115], a[80:83], a[180:183], v[112:115]
    ds_read_b64_tr_b16 a[36:37], v223 offset:8192
    ds_read_b64_tr_b16 a[40:41], v222 offset:8704
    v_mfma_f32_16x16x32_bf16 v[116:119], a[84:87], a[180:183], v[116:119]
    buffer_load_dwordx4 a[224:227], v230, s[36:39], s3 offen sc1
    v_mfma_f32_16x16x32_bf16 v[116:119], a[68:71], a[176:179], v[116:119]
    ds_read_b64_tr_b16 a[44:45], v223 offset:8704
    ds_read_b64_tr_b16 v[34:35], v212 offset:2048
    v_mfma_f32_16x16x32_bf16 v[120:123], a[72:75], a[176:179], v[120:123]
    ds_read_b64_tr_b16 v[38:39], v213 offset:2048
    ds_read_b64_tr_b16 v[42:43], v212 offset:2560
    v_mfma_f32_16x16x32_bf16 v[120:123], a[88:91], a[180:183], v[120:123]
    ds_read_b64_tr_b16 v[46:47], v213 offset:2560
    buffer_load_dwordx4 a[228:231], v230, s[36:39], s53 offen sc1
    v_mfma_f32_16x16x32_bf16 v[124:127], a[92:95], a[180:183], v[124:127]
    ds_read_b64_tr_b16 v[48:49], v212 offset:4096
    v_mfma_f32_16x16x32_bf16 v[124:127], a[76:79], a[176:179], v[124:127]
    s_waitcnt vmcnt(10)
    v_lshlrev_b32 v168, 16, v148
    v_and_b32 v169, 0xffff0000, v148
    v_mfma_f32_16x16x32_bf16 v[96:99], a[64:67], a[184:187], v[96:99]
    ds_read_b64_tr_b16 a[34:35], v222 offset:45056
    v_mfma_f32_16x16x32_bf16 v[96:99], a[80:83], a[188:191], v[96:99]
    ds_read_b64_tr_b16 a[38:39], v223 offset:45056
    ds_read_b64_tr_b16 a[42:43], v222 offset:45568
    v_mfma_f32_16x16x32_bf16 v[100:103], a[84:87], a[188:191], v[100:103]
    buffer_load_dwordx4 a[232:235], v229, s[36:39], s3 offen sc1
    v_mfma_f32_16x16x32_bf16 v[100:103], a[68:71], a[184:187], v[100:103]
    ds_read_b64_tr_b16 a[46:47], v223 offset:45568
    ds_read_b64_tr_b16 v[52:53], v213 offset:4096
    v_mfma_f32_16x16x32_bf16 v[104:107], a[72:75], a[184:187], v[104:107]
    ds_read_b64_tr_b16 v[56:57], v212 offset:4608
    ds_read_b64_tr_b16 v[60:61], v213 offset:4608
    v_mfma_f32_16x16x32_bf16 v[104:107], a[88:91], a[188:191], v[104:107]
    ds_read_b64_tr_b16 v[50:51], v212 offset:6144
    buffer_load_dwordx4 a[236:239], v229, s[36:39], s53 offen sc1
    v_mfma_f32_16x16x32_bf16 v[108:111], a[92:95], a[188:191], v[108:111]
    ds_read_b64_tr_b16 v[54:55], v213 offset:6144
    v_mfma_f32_16x16x32_bf16 v[108:111], a[76:79], a[184:187], v[108:111]
    s_waitcnt vmcnt(10)
    v_lshlrev_b32 v170, 16, v149
    v_and_b32 v171, 0xffff0000, v149
    v_mfma_f32_16x16x32_bf16 v[80:83], a[64:67], a[192:195], v[80:83]
    ds_read_b64_tr_b16 v[58:59], v212 offset:6656
    v_mfma_f32_16x16x32_bf16 v[80:83], a[80:83], a[196:199], v[80:83]
    ds_read_b64_tr_b16 v[62:63], v213 offset:6656
    s_add_u32 s3, s10, 4096
    v_mfma_f32_16x16x32_bf16 v[84:87], a[84:87], a[196:199], v[84:87]
    buffer_load_dwordx4 a[176:179], v232, s[36:39], s3 offen sc1
    v_mfma_f32_16x16x32_bf16 v[84:87], a[68:71], a[192:195], v[84:87]
    ds_read_b64_tr_b16 v[128:129], v210 offset:13312
    v_mfma_f32_16x16x32_bf16 v[88:91], a[72:75], a[192:195], v[88:91]
    ds_read_b64_tr_b16 v[132:133], v211 offset:13312
    ds_read_b64_tr_b16 v[136:137], v210 offset:13824
    v_mfma_f32_16x16x32_bf16 v[88:91], a[88:91], a[196:199], v[88:91]
    s_add_u32 s53, s11, 4096
    v_mfma_f32_16x16x32_bf16 v[92:95], a[92:95], a[196:199], v[92:95]
    buffer_load_dwordx4 a[180:183], v232, s[36:39], s53 offen sc1
    v_mfma_f32_16x16x32_bf16 v[92:95], a[76:79], a[192:195], v[92:95]
    s_waitcnt vmcnt(10)
    v_lshlrev_b32 v172, 16, v150
    v_and_b32 v173, 0xffff0000, v150
    v_mfma_f32_16x16x32_bf16 v[64:67], a[64:67], a[200:203], v[64:67]
    ds_read_b64_tr_b16 v[140:141], v211 offset:13824
    v_mfma_f32_16x16x32_bf16 v[64:67], a[80:83], a[204:207], v[64:67]
    ds_read_b64_tr_b16 v[130:131], v210 offset:15360
    s_add_u32 s3, s0, 8192
    v_mfma_f32_16x16x32_bf16 v[68:71], a[84:87], a[204:207], v[68:71]
    buffer_load_dwordx4 a[184:187], v232, s[36:39], s3 offen sc1
    v_mfma_f32_16x16x32_bf16 v[68:71], a[68:71], a[200:203], v[68:71]
    ds_read_b64_tr_b16 v[134:135], v211 offset:15360
    v_mfma_f32_16x16x32_bf16 v[72:75], a[72:75], a[200:203], v[72:75]
    ds_read_b64_tr_b16 v[138:139], v210 offset:15872
    ds_read_b64_tr_b16 v[142:143], v211 offset:15872
    v_mfma_f32_16x16x32_bf16 v[72:75], a[88:91], a[204:207], v[72:75]
    s_add_u32 s53, s1, 8192
    v_mfma_f32_16x16x32_bf16 v[76:79], a[92:95], a[204:207], v[76:79]
    buffer_load_dwordx4 a[188:191], v232, s[36:39], s53 offen sc1
    v_mfma_f32_16x16x32_bf16 v[76:79], a[76:79], a[200:203], v[76:79]
    s_waitcnt vmcnt(10)
    v_lshlrev_b32 v174, 16, v151
    v_and_b32 v175, 0xffff0000, v151
    v_mfma_f32_16x16x32_bf16 v[112:115], a[96:99], a[208:211], v[112:115]
    ds_read_b64_tr_b16 a[240:241], v210 offset:17408
    v_mfma_f32_16x16x32_bf16 v[112:115], a[112:115], a[212:215], v[112:115]
    s_add_u32 s3, s10, 8192
    buffer_load_dwordx4 a[192:195], v232, s[36:39], s3 offen sc1
    v_mfma_f32_16x16x32_bf16 v[116:119], a[116:119], a[212:215], v[116:119]
    ds_read_b64_tr_b16 a[244:245], v211 offset:17408
    v_mfma_f32_16x16x32_bf16 v[116:119], a[100:103], a[208:211], v[116:119]
    ds_read_b64_tr_b16 a[248:249], v210 offset:17920
    v_mfma_f32_16x16x32_bf16 v[120:123], a[104:107], a[208:211], v[120:123]
    ds_read_b64_tr_b16 a[252:253], v211 offset:17920
    v_mfma_f32_16x16x32_bf16 v[120:123], a[120:123], a[212:215], v[120:123]
    s_add_u32 s53, s11, 8192
    v_mfma_f32_16x16x32_bf16 v[124:127], a[124:127], a[212:215], v[124:127]
    buffer_load_dwordx4 a[196:199], v232, s[36:39], s53 offen sc1
    v_mfma_f32_16x16x32_bf16 v[124:127], a[108:111], a[208:211], v[124:127]
    ds_read_b64_tr_b16 a[242:243], v210 offset:19456
    s_waitcnt vmcnt(10)
    v_mfma_f32_16x16x32_bf16 v[96:99], a[96:99], a[216:219], v[96:99]
    ds_read_b64_tr_b16 a[246:247], v211 offset:19456
    v_mfma_f32_16x16x32_bf16 v[96:99], a[112:115], a[220:223], v[96:99]
    s_add_u32 s3, s10, 4096
    buffer_load_dwordx4 a[200:203], v231, s[36:39], s3 offen sc1
    v_mfma_f32_16x16x32_bf16 v[100:103], a[116:119], a[220:223], v[100:103]
    ds_read_b64_tr_b16 a[250:251], v210 offset:19968
    v_mfma_f32_16x16x32_bf16 v[100:103], a[100:103], a[216:219], v[100:103]
    ds_read_b64_tr_b16 a[254:255], v211 offset:19968
    v_mfma_f32_16x16x32_bf16 v[104:107], a[104:107], a[216:219], v[104:107]
    ds_read_b64_tr_b16 v[144:145], v212 offset:11264
    v_mfma_f32_16x16x32_bf16 v[104:107], a[120:123], a[220:223], v[104:107]
    s_add_u32 s53, s11, 4096
    v_mfma_f32_16x16x32_bf16 v[108:111], a[124:127], a[220:223], v[108:111]
    buffer_load_dwordx4 a[204:207], v231, s[36:39], s53 offen sc1
    v_mfma_f32_16x16x32_bf16 v[108:111], a[108:111], a[216:219], v[108:111]
    ds_read_b64_tr_b16 v[148:149], v213 offset:11264
    s_waitcnt vmcnt(10)
    v_mfma_f32_16x16x32_bf16 v[80:83], a[96:99], a[224:227], v[80:83]
    ds_read_b64_tr_b16 v[152:153], v212 offset:11776
    v_mfma_f32_16x16x32_bf16 v[80:83], a[112:115], a[228:231], v[80:83]
    s_add_u32 s3, s0, 8192
    buffer_load_dwordx4 a[208:211], v231, s[36:39], s3 offen sc1
    v_mfma_f32_16x16x32_bf16 v[84:87], a[116:119], a[228:231], v[84:87]
    ds_read_b64_tr_b16 v[156:157], v213 offset:11776
    v_mfma_f32_16x16x32_bf16 v[84:87], a[100:103], a[224:227], v[84:87]
    ds_read_b64_tr_b16 v[146:147], v212 offset:13312
    v_mfma_f32_16x16x32_bf16 v[88:91], a[104:107], a[224:227], v[88:91]
    ds_read_b64_tr_b16 v[150:151], v213 offset:13312
    v_mfma_f32_16x16x32_bf16 v[88:91], a[120:123], a[228:231], v[88:91]
    s_add_u32 s53, s1, 8192
    v_mfma_f32_16x16x32_bf16 v[92:95], a[124:127], a[228:231], v[92:95]
    buffer_load_dwordx4 a[212:215], v231, s[36:39], s53 offen sc1
    v_mfma_f32_16x16x32_bf16 v[92:95], a[108:111], a[224:227], v[92:95]
    ds_read_b64_tr_b16 v[154:155], v212 offset:13824
    s_waitcnt vmcnt(10)
    v_mfma_f32_16x16x32_bf16 v[64:67], a[96:99], a[232:235], v[64:67]
    ds_read_b64_tr_b16 v[158:159], v213 offset:13824
    v_mfma_f32_16x16x32_bf16 v[64:67], a[112:115], a[236:239], v[64:67]
    s_add_u32 s3, s10, 8192
    buffer_load_dwordx4 a[216:219], v231, s[36:39], s3 offen sc1
    v_mfma_f32_16x16x32_bf16 v[68:71], a[116:119], a[236:239], v[68:71]
    ds_read_b64_tr_b16 a[48:49], v212 offset:15360
    v_mfma_f32_16x16x32_bf16 v[68:71], a[100:103], a[232:235], v[68:71]
    ds_read_b64_tr_b16 a[52:53], v213 offset:15360
    v_mfma_f32_16x16x32_bf16 v[72:75], a[104:107], a[232:235], v[72:75]
    ds_read_b64_tr_b16 a[56:57], v212 offset:15872
    v_mfma_f32_16x16x32_bf16 v[72:75], a[120:123], a[236:239], v[72:75]
    s_add_u32 s53, s11, 8192
    v_mfma_f32_16x16x32_bf16 v[76:79], a[124:127], a[236:239], v[76:79]
    buffer_load_dwordx4 a[220:223], v231, s[36:39], s53 offen sc1
    v_mfma_f32_16x16x32_bf16 v[76:79], a[108:111], a[232:235], v[76:79]
    ds_read_b64_tr_b16 a[60:61], v213 offset:15872
    s_waitcnt vmcnt(10)
    v_mfma_f32_16x16x32_bf16 v[112:115], a[128:131], a[176:179], v[112:115]
    ds_read_b64_tr_b16 a[50:51], v212 offset:17408
    v_mfma_f32_16x16x32_bf16 v[112:115], a[144:147], a[180:183], v[112:115]
    s_add_u32 s3, s10, 4096
    buffer_load_dwordx4 a[224:227], v230, s[36:39], s3 offen sc1
    v_mfma_f32_16x16x32_bf16 v[116:119], a[148:151], a[180:183], v[116:119]
    ds_read_b64_tr_b16 a[54:55], v213 offset:17408
    v_mfma_f32_16x16x32_bf16 v[116:119], a[132:135], a[176:179], v[116:119]
    ds_read_b64_tr_b16 a[58:59], v212 offset:17920
    v_mfma_f32_16x16x32_bf16 v[120:123], a[136:139], a[176:179], v[120:123]
    ds_read_b64_tr_b16 a[62:63], v213 offset:17920
    v_mfma_f32_16x16x32_bf16 v[120:123], a[152:155], a[180:183], v[120:123]
    s_add_u32 s53, s11, 4096
    v_mfma_f32_16x16x32_bf16 v[124:127], a[156:159], a[180:183], v[124:127]
    buffer_load_dwordx4 a[228:231], v230, s[36:39], s53 offen sc1
    v_mfma_f32_16x16x32_bf16 v[124:127], a[140:143], a[176:179], v[124:127]
    ds_read_b64_tr_b16 a[64:65], v210 offset:24576
    s_waitcnt vmcnt(10)
    v_mfma_f32_16x16x32_bf16 v[112:115], a[160:163], a[184:187], v[112:115]
    ds_read_b64_tr_b16 a[68:69], v211 offset:24576
    v_mfma_f32_16x16x32_bf16 v[112:115], a[0:3], a[188:191], v[112:115]
    buffer_load_dword v246, v250, s[36:39], s48 offen sc1
    v_mfma_f32_16x16x32_bf16 v[116:119], a[4:7], a[188:191], v[116:119]
    s_add_u32 s3, s0, 8192
    buffer_load_dwordx4 a[232:235], v230, s[36:39], s3 offen sc1
    v_mfma_f32_16x16x32_bf16 v[116:119], a[164:167], a[184:187], v[116:119]
    ds_read_b64_tr_b16 a[72:73], v210 offset:25088
    v_mfma_f32_16x16x32_bf16 v[120:123], a[168:171], a[184:187], v[120:123]
    ds_read_b64_tr_b16 a[76:77], v211 offset:25088
    v_mfma_f32_16x16x32_bf16 v[120:123], a[8:11], a[188:191], v[120:123]
    ds_read_b64_tr_b16 a[66:67], v210 offset:26624
    v_mfma_f32_16x16x32_bf16 v[124:127], a[12:15], a[188:191], v[124:127]
    s_add_u32 s53, s1, 8192
    buffer_load_dwordx4 a[236:239], v230, s[36:39], s53 offen sc1
    v_mfma_f32_16x16x32_bf16 v[124:127], a[172:175], a[184:187], v[124:127]
    ds_read_b64_tr_b16 a[70:71], v211 offset:26624
    s_waitcnt vmcnt(11) lgkmcnt(14)
    v_mfma_f32_16x16x32_bf16 v[112:115], a[16:19], a[192:195], v[112:115]
    v_add_u32_e64 v182, s96, v254
    v_mfma_f32_16x16x32_bf16 v[112:115], a[32:35], a[196:199], v[112:115]
    s_add_u32 s3, s10, 8192
    v_add_u32 v183, 90112, v182
    v_mfma_f32_16x16x32_bf16 v[116:119], a[36:39], a[196:199], v[116:119]
    buffer_load_dwordx4 a[176:179], v230, s[36:39], s3 offen sc1
    v_mfma_f32_16x16x32_bf16 v[116:119], a[20:23], a[192:195], v[116:119]
    ds_read_b64_tr_b16 a[74:75], v210 offset:27136
    s_add_u32 s49, s43, 16384
    v_mfma_f32_16x16x32_bf16 v[120:123], a[24:27], a[192:195], v[120:123]
    ds_read_b64_tr_b16 a[78:79], v211 offset:27136
    v_mfma_f32_16x16x32_bf16 v[120:123], a[40:43], a[196:199], v[120:123]
    ds_read_b64_tr_b16 a[80:81], v210 offset:28672
    s_add_u32 s53, s11, 8192
    v_mfma_f32_16x16x32_bf16 v[124:127], a[44:47], a[196:199], v[124:127]
    buffer_load_dwordx4 a[180:183], v230, s[36:39], s53 offen sc1
    v_mfma_f32_16x16x32_bf16 v[124:127], a[28:31], a[192:195], v[124:127]
    ds_read_b64_tr_b16 a[84:85], v211 offset:28672
    ds_read_b64_tr_b16 a[88:89], v210 offset:29184
    s_waitcnt vmcnt(11)
    v_mfma_f32_16x16x32_bf16 v[96:99], a[128:131], a[200:203], v[96:99]
    s_xor_b32 s88, s82, 1
    s_mul_i32 s88, s88, 11264
    v_mfma_f32_16x16x32_bf16 v[96:99], a[144:147], a[204:207], v[96:99]
    ds_write_b128 v182, v[112:115] offset:8192
    s_add_u32 s3, s10, 4096
    v_add_u32_e64 v184, s88, v254
    v_mfma_f32_16x16x32_bf16 v[100:103], a[148:151], a[204:207], v[100:103]
    buffer_load_dwordx4 a[184:187], v229, s[36:39], s3 offen sc1
    v_mfma_f32_16x16x32_bf16 v[100:103], a[132:135], a[200:203], v[100:103]
    ds_read_b64_tr_b16 a[92:93], v211 offset:29184
    v_add_u32 v185, 90112, v184
    v_mfma_f32_16x16x32_bf16 v[104:107], a[136:139], a[200:203], v[104:107]
    ds_read_b64_tr_b16 a[82:83], v210 offset:30720
    v_mfma_f32_16x16x32_bf16 v[104:107], a[152:155], a[204:207], v[104:107]
    ds_write_b128 v182, v[116:119] offset:9216
    ds_read_b64_tr_b16 a[86:87], v211 offset:30720
    s_add_u32 s53, s11, 4096
    v_mfma_f32_16x16x32_bf16 v[108:111], a[156:159], a[204:207], v[108:111]
    buffer_load_dwordx4 a[188:191], v229, s[36:39], s53 offen sc1
    v_mfma_f32_16x16x32_bf16 v[108:111], a[140:143], a[200:203], v[108:111]
    ds_read_b64_tr_b16 a[90:91], v210 offset:31232
    ds_read_b64_tr_b16 a[94:95], v211 offset:31232
    s_waitcnt vmcnt(11)
    v_mfma_f32_16x16x32_bf16 v[96:99], a[160:163], a[208:211], v[96:99]
    s_xor_b32 s88, s82, 2
    s_mul_i32 s88, s88, 11264
    v_mfma_f32_16x16x32_bf16 v[96:99], a[0:3], a[212:215], v[96:99]
    ds_write_b128 v182, v[120:123] offset:10240
    s_add_u32 s3, s0, 8192
    v_add_u32_e64 v186, s88, v254
    v_mfma_f32_16x16x32_bf16 v[100:103], a[4:7], a[212:215], v[100:103]
    buffer_load_dwordx4 a[192:195], v229, s[36:39], s3 offen sc1
    v_add_u32 v187, 90112, v186
    v_mfma_f32_16x16x32_bf16 v[100:103], a[164:167], a[208:211], v[100:103]
    ds_read_b64_tr_b16 a[96:97], v212 offset:22528
    v_mfma_f32_16x16x32_bf16 v[104:107], a[168:171], a[208:211], v[104:107]
    ds_read_b64_tr_b16 a[100:101], v213 offset:22528
    ds_read_b64_tr_b16 a[104:105], v212 offset:23040
    v_mfma_f32_16x16x32_bf16 v[104:107], a[8:11], a[212:215], v[104:107]
    ds_write_b128 v182, v[124:127] offset:45056
    ds_read_b64_tr_b16 a[108:109], v213 offset:23040
    v_mfma_f32_16x16x32_bf16 v[108:111], a[12:15], a[212:215], v[108:111]
    s_add_u32 s53, s1, 8192
    buffer_load_dwordx4 a[196:199], v229, s[36:39], s53 offen sc1
    v_mfma_f32_16x16x32_bf16 v[108:111], a[172:175], a[208:211], v[108:111]
    ds_read_b64_tr_b16 a[98:99], v212 offset:24576
    v_mov_b32 v180, 0xbfb8aa3b
    s_waitcnt vmcnt(11)
    v_mfma_f32_16x16x32_bf16 v[96:99], a[16:19], a[216:219], v[96:99]
    s_xor_b32 s88, s82, 3
    s_mul_i32 s88, s88, 11264
    v_mfma_f32_16x16x32_bf16 v[96:99], a[32:35], a[220:223], v[96:99]
    s_add_u32 s3, s10, 8192
    v_add_u32_e64 v188, s88, v254
    v_mfma_f32_16x16x32_bf16 v[100:103], a[36:39], a[220:223], v[100:103]
    buffer_load_dwordx4 a[200:203], v229, s[36:39], s3 offen sc1
    v_mfma_f32_16x16x32_bf16 v[100:103], a[20:23], a[216:219], v[100:103]
    ds_read_b64_tr_b16 a[102:103], v213 offset:24576
    v_add_u32 v189, 90112, v188
    v_mfma_f32_16x16x32_bf16 v[104:107], a[24:27], a[216:219], v[104:107]
    ds_read_b64_tr_b16 a[106:107], v212 offset:25088
    v_mfma_f32_16x16x32_bf16 v[104:107], a[40:43], a[220:223], v[104:107]
    ds_read_b64_tr_b16 a[110:111], v213 offset:25088
    s_add_u32 s53, s11, 8192
    v_mfma_f32_16x16x32_bf16 v[108:111], a[44:47], a[220:223], v[108:111]
    buffer_load_dwordx4 a[204:207], v229, s[36:39], s53 offen sc1
    v_mfma_f32_16x16x32_bf16 v[108:111], a[28:31], a[216:219], v[108:111]
    ds_read_b64_tr_b16 a[112:113], v212 offset:26624
    ds_read_b64_tr_b16 a[116:117], v213 offset:26624
    s_waitcnt vmcnt(11)
    v_mfma_f32_16x16x32_bf16 v[80:83], a[128:131], a[224:227], v[80:83]
    ds_read_b64_tr_b16 a[120:121], v212 offset:27136
    v_mfma_f32_16x16x32_bf16 v[80:83], a[144:147], a[228:231], v[80:83]
    ds_write_b128 v182, v[96:99] offset:4096
    s_waitcnt vmcnt(10)
    v_cmp_le_u32 vcc, 1, v246
    s_nop 1
    s_cmp_eq_u64 vcc, -1
    s_cbranch_scc0 L_ps_spin
L_ps_ok:
    s_barrier
    buffer_load_dwordx4 a[208:211], v229, s[36:39], s40 offen sc1
    v_mfma_f32_16x16x32_bf16 v[84:87], a[148:151], a[228:231], v[84:87]
    ds_read_b64_tr_b16 a[124:125], v213 offset:27136
    v_mfma_f32_16x16x32_bf16 v[84:87], a[132:135], a[224:227], v[84:87]
    ds_read_b64_tr_b16 a[114:115], v212 offset:28672
    v_mfma_f32_16x16x32_bf16 v[88:91], a[136:139], a[224:227], v[88:91]
    ds_read_b64_tr_b16 a[118:119], v213 offset:28672
    v_mfma_f32_16x16x32_bf16 v[88:91], a[152:155], a[228:231], v[88:91]
    ds_write_b128 v182, v[100:103] offset:5120
    v_mfma_f32_16x16x32_bf16 v[92:95], a[156:159], a[228:231], v[92:95]
    s_xor_b32 s53, s40, 4096
    buffer_load_dwordx4 a[212:215], v229, s[36:39], s53 offen sc1
    v_mfma_f32_16x16x32_bf16 v[92:95], a[140:143], a[224:227], v[92:95]
    ds_read_b64_tr_b16 a[122:123], v212 offset:29184
    s_waitcnt vmcnt(10)
    v_mfma_f32_16x16x32_bf16 v[80:83], a[160:163], a[232:235], v[80:83]
    s_xor_b32 s3, s40, 8192
    v_mfma_f32_16x16x32_bf16 v[80:83], a[0:3], a[236:239], v[80:83]
    ds_write_b128 v182, v[104:107] offset:6144
    v_mfma_f32_16x16x32_bf16 v[84:87], a[4:7], a[236:239], v[84:87]
    buffer_load_dwordx4 a[216:219], v229, s[36:39], s3 offen sc1
    v_mfma_f32_16x16x32_bf16 v[84:87], a[164:167], a[232:235], v[84:87]
    ds_read_b64_tr_b16 a[126:127], v213 offset:29184
    v_mfma_f32_16x16x32_bf16 v[88:91], a[168:171], a[232:235], v[88:91]
    v_mfma_f32_16x16x32_bf16 v[88:91], a[8:11], a[236:239], v[88:91]
    ds_write_b128 v182, v[108:111] offset:7168
    v_mfma_f32_16x16x32_bf16 v[92:95], a[12:15], a[236:239], v[92:95]
    s_xor_b32 s53, s40, 12288
    v_mfma_f32_16x16x32_bf16 v[92:95], a[172:175], a[232:235], v[92:95]
    buffer_load_dwordx4 a[220:223], v229, s[36:39], s53 offen sc1
    s_waitcnt vmcnt(10)
    v_mfma_f32_16x16x32_bf16 v[80:83], a[16:19], a[176:179], v[80:83]
    s_xor_b32 s3, s40, 16384
    v_mfma_f32_16x16x32_bf16 v[80:83], a[32:35], a[180:183], v[80:83]
    buffer_load_dwordx4 a[224:227], v229, s[36:39], s3 offen sc1
    v_mfma_f32_16x16x32_bf16 v[84:87], a[36:39], a[180:183], v[84:87]
    v_mfma_f32_16x16x32_bf16 v[84:87], a[20:23], a[176:179], v[84:87]
    v_mfma_f32_16x16x32_bf16 v[88:91], a[24:27], a[176:179], v[88:91]
    s_xor_b32 s53, s40, 20480
    v_mfma_f32_16x16x32_bf16 v[88:91], a[40:43], a[180:183], v[88:91]
    buffer_load_dwordx4 a[228:231], v229, s[36:39], s53 offen sc1
    v_mfma_f32_16x16x32_bf16 v[92:95], a[44:47], a[180:183], v[92:95]
    v_mfma_f32_16x16x32_bf16 v[92:95], a[28:31], a[176:179], v[92:95]
    s_waitcnt vmcnt(10)
    v_mfma_f32_16x16x32_bf16 v[64:67], a[128:131], a[184:187], v[64:67]
    s_xor_b32 s3, s40, 24576
    v_mfma_f32_16x16x32_bf16 v[64:67], a[144:147], a[188:191], v[64:67]
    ds_write_b128 v182, v[80:83] offset:0
    v_mfma_f32_16x16x32_bf16 v[68:71], a[148:151], a[188:191], v[68:71]
    buffer_load_dwordx4 a[232:235], v229, s[36:39], s3 offen sc1
    v_mfma_f32_16x16x32_bf16 v[68:71], a[132:135], a[184:187], v[68:71]
    v_mfma_f32_16x16x32_bf16 v[72:75], a[136:139], a[184:187], v[72:75]
    s_xor_b32 s53, s40, 28672
    v_mfma_f32_16x16x32_bf16 v[72:75], a[152:155], a[188:191], v[72:75]
    ds_write_b128 v182, v[84:87] offset:1024
    v_mfma_f32_16x16x32_bf16 v[76:79], a[156:159], a[188:191], v[76:79]
    buffer_load_dwordx4 a[236:239], v229, s[36:39], s53 offen sc1
    v_mfma_f32_16x16x32_bf16 v[76:79], a[140:143], a[184:187], v[76:79]
    s_waitcnt vmcnt(10)
    v_mfma_f32_16x16x32_bf16 v[64:67], a[160:163], a[192:195], v[64:67]
    buffer_load_dwordx4 a[176:179], v229, s[36:39], s90 offen sc1
    v_mfma_f32_16x16x32_bf16 v[64:67], a[0:3], a[196:199], v[64:67]
    ds_write_b128 v182, v[88:91] offset:2048
    v_mfma_f32_16x16x32_bf16 v[68:71], a[4:7], a[196:199], v[68:71]
    v_mfma_f32_16x16x32_bf16 v[68:71], a[164:167], a[192:195], v[68:71]
    s_xor_b32 s53, s90, 4096
    v_mfma_f32_16x16x32_bf16 v[72:75], a[168:171], a[192:195], v[72:75]
    v_mfma_f32_16x16x32_bf16 v[72:75], a[8:11], a[196:199], v[72:75]
    ds_write_b128 v182, v[92:95] offset:3072
    v_mfma_f32_16x16x32_bf16 v[76:79], a[12:15], a[196:199], v[76:79]
    buffer_load_dwordx4 a[180:183], v229, s[36:39], s53 offen sc1
    v_mfma_f32_16x16x32_bf16 v[76:79], a[172:175], a[192:195], v[76:79]
    s_waitcnt lgkmcnt(0)
    s_barrier
    s_waitcnt vmcnt(10)
    v_mfma_f32_16x16x32_bf16 v[64:67], a[16:19], a[200:203], v[64:67]
    ds_read_b128 v[80:83], v184 offset:0
    v_mfma_f32_16x16x32_bf16 v[64:67], a[32:35], a[204:207], v[64:67]
    s_xor_b32 s3, s90, 8192
    buffer_load_dwordx4 a[184:187], v229, s[36:39], s3 offen sc1
    v_mfma_f32_16x16x32_bf16 v[68:71], a[36:39], a[204:207], v[68:71]
    ds_read_b128 v[96:99], v186 offset:4096
    v_mfma_f32_16x16x32_bf16 v[68:71], a[20:23], a[200:203], v[68:71]
    ds_read_b128 v[112:115], v188 offset:8192
    v_mfma_f32_16x16x32_bf16 v[72:75], a[24:27], a[200:203], v[72:75]
    ds_read_b128 v[84:87], v184 offset:1024
    v_mfma_f32_16x16x32_bf16 v[72:75], a[40:43], a[204:207], v[72:75]
    s_xor_b32 s53, s90, 12288
    buffer_load_dwordx4 a[188:191], v229, s[36:39], s53 offen sc1
    v_mfma_f32_16x16x32_bf16 v[76:79], a[44:47], a[204:207], v[76:79]
    ds_read_b128 v[100:103], v186 offset:5120
    v_mfma_f32_16x16x32_bf16 v[76:79], a[28:31], a[200:203], v[76:79]
    ds_read_b128 v[116:119], v188 offset:9216
    s_waitcnt vmcnt(10)
    v_mfma_f32_16x16x32_bf16 v[0:3], v[192:195], a[208:211], 0
    ds_read_b128 v[88:91], v184 offset:2048
    ds_read_b128 v[104:107], v186 offset:6144
    v_mfma_f32_16x16x32_bf16 v[0:3], v[16:19], a[212:215], v[0:3]
    ds_read_b128 v[120:123], v188 offset:10240
    s_xor_b32 s3, s90, 16384
    v_mfma_f32_16x16x32_bf16 v[4:7], v[20:23], a[212:215], 0
    buffer_load_dwordx4 a[192:195], v229, s[36:39], s3 offen sc1
    ds_read_b128 v[92:95], v184 offset:3072
    v_mfma_f32_16x16x32_bf16 v[4:7], v[196:199], a[208:211], v[4:7]
    ds_read_b128 v[108:111], v186 offset:7168
    ds_read_b128 v[124:127], v188 offset:45056
    v_mfma_f32_16x16x32_bf16 v[8:11], v[200:203], a[208:211], 0
    ds_read_b64_tr_b16 a[128:129], v210 offset:35840
    ds_read_b64_tr_b16 a[132:133], v211 offset:35840
    ds_read_b64_tr_b16 a[136:137], v210 offset:36352
    v_mfma_f32_16x16x32_bf16 v[8:11], v[24:27], a[212:215], v[8:11]
    ds_read_b64_tr_b16 a[140:141], v211 offset:36352
    s_xor_b32 s53, s90, 20480
    v_mfma_f32_16x16x32_bf16 v[12:15], v[28:31], a[212:215], 0
    buffer_load_dwordx4 a[196:199], v229, s[36:39], s53 offen sc1
    ds_read_b64_tr_b16 a[130:131], v210 offset:37888
    v_mfma_f32_16x16x32_bf16 v[12:15], v[204:207], a[208:211], v[12:15]
    ds_read_b64_tr_b16 a[134:135], v211 offset:37888
    ds_read_b64_tr_b16 a[138:139], v210 offset:38400
    ds_read_b64_tr_b16 a[142:143], v211 offset:38400
    s_waitcnt vmcnt(10)
    v_mfma_f32_16x16x32_bf16 v[0:3], v[32:35], a[216:219], v[0:3]
    ds_read_b64_tr_b16 a[144:145], v210 offset:39936
    v_mfma_f32_16x16x32_bf16 v[0:3], v[48:51], a[220:223], v[0:3]
    ds_read_b64_tr_b16 a[148:149], v211 offset:39936
    s_xor_b32 s3, s90, 24576
    v_mfma_f32_16x16x32_bf16 v[4:7], v[52:55], a[220:223], v[4:7]
    buffer_load_dwordx4 a[200:203], v229, s[36:39], s3 offen sc1
    v_mfma_f32_16x16x32_bf16 v[4:7], v[36:39], a[216:219], v[4:7]
    ds_read_b64_tr_b16 a[152:153], v210 offset:40448
    ds_read_b64_tr_b16 a[156:157], v211 offset:40448
    v_mfma_f32_16x16x32_bf16 v[8:11], v[40:43], a[216:219], v[8:11]
    ds_read_b64_tr_b16 a[146:147], v210 offset:41984
    v_mfma_f32_16x16x32_bf16 v[8:11], v[56:59], a[220:223], v[8:11]
    ds_read_b64_tr_b16 a[150:151], v211 offset:41984
    s_xor_b32 s53, s90, 28672
    v_mfma_f32_16x16x32_bf16 v[12:15], v[60:63], a[220:223], v[12:15]
    buffer_load_dwordx4 a[204:207], v229, s[36:39], s53 offen sc1
    v_mfma_f32_16x16x32_bf16 v[12:15], v[44:47], a[216:219], v[12:15]
    ds_read_b64_tr_b16 a[154:155], v210 offset:42496
    ds_read_b64_tr_b16 a[158:159], v211 offset:42496
    s_waitcnt vmcnt(10)
    v_mfma_f32_16x16x32_bf16 v[0:3], v[128:131], a[224:227], v[0:3]
    ds_read_b64_tr_b16 a[160:161], v212 offset:33792
    v_mfma_f32_16x16x32_bf16 v[0:3], a[240:243], a[228:231], v[0:3]
    ds_read_b64_tr_b16 a[164:165], v213 offset:33792
    v_mfma_f32_16x16x32_bf16 v[4:7], a[244:247], a[228:231], v[4:7]
    ds_read_b64_tr_b16 a[168:169], v212 offset:34304
    v_mfma_f32_16x16x32_bf16 v[4:7], v[132:135], a[224:227], v[4:7]
    ds_read_b64_tr_b16 a[172:173], v213 offset:34304
    v_mfma_f32_16x16x32_bf16 v[8:11], v[136:139], a[224:227], v[8:11]
    ds_read_b64_tr_b16 a[162:163], v212 offset:35840
    v_mfma_f32_16x16x32_bf16 v[8:11], a[248:251], a[228:231], v[8:11]
    ds_read_b64_tr_b16 a[166:167], v213 offset:35840
    v_mfma_f32_16x16x32_bf16 v[12:15], a[252:255], a[228:231], v[12:15]
    ds_read_b64_tr_b16 a[170:171], v212 offset:36352
    v_mfma_f32_16x16x32_bf16 v[12:15], v[140:143], a[224:227], v[12:15]
    ds_read_b64_tr_b16 a[174:175], v213 offset:36352
    s_waitcnt vmcnt(8)
    v_mfma_f32_16x16x32_bf16 v[0:3], v[144:147], a[232:235], v[0:3]
    ds_read_b64_tr_b16 a[0:1], v212 offset:37888
    v_mfma_f32_16x16x32_bf16 v[0:3], a[48:51], a[236:239], v[0:3]
    ds_read_b64_tr_b16 a[4:5], v213 offset:37888
    v_mfma_f32_16x16x32_bf16 v[4:7], a[52:55], a[236:239], v[4:7]
    ds_read_b64_tr_b16 a[8:9], v212 offset:38400
    v_mfma_f32_16x16x32_bf16 v[4:7], v[148:151], a[232:235], v[4:7]
    ds_read_b64_tr_b16 a[12:13], v213 offset:38400
    v_mfma_f32_16x16x32_bf16 v[8:11], v[152:155], a[232:235], v[8:11]
    ds_read_b64_tr_b16 a[2:3], v212 offset:39936
    v_mfma_f32_16x16x32_bf16 v[8:11], a[56:59], a[236:239], v[8:11]
    ds_read_b64_tr_b16 a[6:7], v213 offset:39936
    v_mfma_f32_16x16x32_bf16 v[12:15], a[60:63], a[236:239], v[12:15]
    ds_read_b64_tr_b16 a[10:11], v212 offset:40448
    v_mfma_f32_16x16x32_bf16 v[12:15], v[156:159], a[232:235], v[12:15]
    ds_read_b64_tr_b16 a[14:15], v213 offset:40448
    s_waitcnt lgkmcnt(14)
    v_pk_add_f32 v[64:65], v[64:65], v[80:81]
    v_pk_add_f32 v[66:67], v[66:67], v[82:83]
    v_pk_add_f32 v[68:69], v[68:69], v[84:85]
    v_pk_add_f32 v[70:71], v[70:71], v[86:87]
    v_pk_add_f32 v[72:73], v[72:73], v[88:89]
    v_pk_add_f32 v[74:75], v[74:75], v[90:91]
    v_pk_add_f32 v[76:77], v[76:77], v[92:93]
    v_pk_add_f32 v[78:79], v[78:79], v[94:95]
    v_pk_add_f32 v[64:65], v[64:65], v[96:97]
    v_pk_add_f32 v[66:67], v[66:67], v[98:99]
    v_pk_add_f32 v[68:69], v[68:69], v[100:101]
    v_pk_add_f32 v[70:71], v[70:71], v[102:103]
    v_pk_add_f32 v[72:73], v[72:73], v[104:105]
    v_pk_add_f32 v[74:75], v[74:75], v[106:107]
    v_pk_add_f32 v[76:77], v[76:77], v[108:109]
    v_pk_add_f32 v[78:79], v[78:79], v[110:111]
    v_pk_add_f32 v[64:65], v[64:65], v[112:113]
    v_pk_add_f32 v[66:67], v[66:67], v[114:115]
    v_pk_add_f32 v[68:69], v[68:69], v[116:117]
    v_pk_add_f32 v[70:71], v[70:71], v[118:119]
    v_pk_add_f32 v[72:73], v[72:73], v[120:121]
    v_pk_add_f32 v[74:75], v[74:75], v[122:123]
    v_pk_add_f32 v[76:77], v[76:77], v[124:125]
    v_pk_add_f32 v[78:79], v[78:79], v[126:127]
    v_pk_mul_f32 v[192:193], v[64:65], v[180:181] op_sel_hi:[1,0]
    v_pk_mul_f32 v[194:195], v[66:67], v[180:181] op_sel_hi:[1,0]
    v_pk_mul_f32 v[196:197], v[68:69], v[180:181] op_sel_hi:[1,0]
    v_pk_mul_f32 v[198:199], v[70:71], v[180:181] op_sel_hi:[1,0]
    v_pk_mul_f32 v[200:201], v[72:73], v[180:181] op_sel_hi:[1,0]
    v_pk_mul_f32 v[202:203], v[74:75], v[180:181] op_sel_hi:[1,0]
    v_pk_mul_f32 v[204:205], v[76:77], v[180:181] op_sel_hi:[1,0]
    v_pk_mul_f32 v[206:207], v[78:79], v[180:181] op_sel_hi:[1,0]
    s_waitcnt vmcnt(6)
    v_mfma_f32_16x16x32_bf16 v[0:3], a[64:67], a[176:179], v[0:3]
    v_exp_f32 v192, v192
    v_mfma_f32_16x16x32_bf16 v[0:3], a[80:83], a[180:183], v[0:3]
    v_exp_f32 v193, v193
    v_mfma_f32_16x16x32_bf16 v[4:7], a[84:87], a[180:183], v[4:7]
    v_exp_f32 v194, v194
    v_mfma_f32_16x16x32_bf16 v[4:7], a[68:71], a[176:179], v[4:7]
    v_exp_f32 v195, v195
    v_mfma_f32_16x16x32_bf16 v[8:11], a[72:75], a[176:179], v[8:11]
    v_exp_f32 v196, v196
    v_mfma_f32_16x16x32_bf16 v[8:11], a[88:91], a[180:183], v[8:11]
    v_exp_f32 v197, v197
    v_mfma_f32_16x16x32_bf16 v[12:15], a[92:95], a[180:183], v[12:15]
    v_exp_f32 v198, v198
    v_mfma_f32_16x16x32_bf16 v[12:15], a[76:79], a[176:179], v[12:15]
    s_waitcnt vmcnt(4)
    v_exp_f32 v199, v199
    v_mfma_f32_16x16x32_bf16 v[0:3], a[96:99], a[184:187], v[0:3]
    v_exp_f32 v200, v200
    v_mfma_f32_16x16x32_bf16 v[0:3], a[112:115], a[188:191], v[0:3]
    v_exp_f32 v201, v201
    v_mfma_f32_16x16x32_bf16 v[4:7], a[116:119], a[188:191], v[4:7]
    v_exp_f32 v202, v202
    v_mfma_f32_16x16x32_bf16 v[4:7], a[100:103], a[184:187], v[4:7]
    v_exp_f32 v203, v203
    v_mfma_f32_16x16x32_bf16 v[8:11], a[104:107], a[184:187], v[8:11]
    v_exp_f32 v204, v204
    v_mfma_f32_16x16x32_bf16 v[8:11], a[120:123], a[188:191], v[8:11]
    v_exp_f32 v205, v205
    v_mfma_f32_16x16x32_bf16 v[12:15], a[124:127], a[188:191], v[12:15]
    v_exp_f32 v206, v206
    v_mfma_f32_16x16x32_bf16 v[12:15], a[108:111], a[184:187], v[12:15]
    v_exp_f32_e64 v207, v207
    v_pk_add_f32 v[192:193], v[192:193], 1.0 op_sel_hi:[1,0]
    v_pk_add_f32 v[194:195], v[194:195], 1.0 op_sel_hi:[1,0]
    v_pk_add_f32 v[196:197], v[196:197], 1.0 op_sel_hi:[1,0]
    v_pk_add_f32 v[198:199], v[198:199], 1.0 op_sel_hi:[1,0]
    v_pk_add_f32 v[200:201], v[200:201], 1.0 op_sel_hi:[1,0]
    v_pk_add_f32 v[202:203], v[202:203], 1.0 op_sel_hi:[1,0]
    v_pk_add_f32 v[204:205], v[204:205], 1.0 op_sel_hi:[1,0]
    v_pk_add_f32 v[206:207], v[206:207], 1.0 op_sel_hi:[1,0]
    s_waitcnt vmcnt(2)
    v_mfma_f32_16x16x32_bf16 v[0:3], a[128:131], a[192:195], v[0:3]
    v_rcp_f32 v192, v192
    v_mfma_f32_16x16x32_bf16 v[0:3], a[144:147], a[196:199], v[0:3]
    v_rcp_f32 v193, v193
    v_mfma_f32_16x16x32_bf16 v[4:7], a[148:151], a[196:199], v[4:7]
    v_rcp_f32 v194, v194
    v_mfma_f32_16x16x32_bf16 v[4:7], a[132:135], a[192:195], v[4:7]
    v_rcp_f32 v195, v195
    v_mfma_f32_16x16x32_bf16 v[8:11], a[136:139], a[192:195], v[8:11]
    v_rcp_f32 v196, v196
    v_mfma_f32_16x16x32_bf16 v[8:11], a[152:155], a[196:199], v[8:11]
    v_rcp_f32 v197, v197
    v_mfma_f32_16x16x32_bf16 v[12:15], a[156:159], a[196:199], v[12:15]
    v_rcp_f32 v198, v198
    v_mfma_f32_16x16x32_bf16 v[12:15], a[140:143], a[192:195], v[12:15]
    s_waitcnt vmcnt(0) lgkmcnt(0)
    v_rcp_f32 v199, v199
    v_mfma_f32_16x16x32_bf16 v[0:3], a[160:163], a[200:203], v[0:3]
    v_rcp_f32 v200, v200
    v_mfma_f32_16x16x32_bf16 v[0:3], a[0:3], a[204:207], v[0:3]
    v_rcp_f32 v201, v201
    v_mfma_f32_16x16x32_bf16 v[4:7], a[4:7], a[204:207], v[4:7]
    v_rcp_f32 v202, v202
    v_mfma_f32_16x16x32_bf16 v[4:7], a[164:167], a[200:203], v[4:7]
    v_rcp_f32 v203, v203
    v_mfma_f32_16x16x32_bf16 v[8:11], a[168:171], a[200:203], v[8:11]
    v_rcp_f32 v204, v204
    v_mfma_f32_16x16x32_bf16 v[8:11], a[8:11], a[204:207], v[8:11]
    v_rcp_f32 v205, v205
    v_mfma_f32_16x16x32_bf16 v[12:15], a[12:15], a[204:207], v[12:15]
    v_rcp_f32 v206, v206
    v_mfma_f32_16x16x32_bf16 v[12:15], a[172:175], a[200:203], v[12:15]
    v_rcp_f32 v207, v207
    v_pk_mul_f32 v[192:193], v[192:193], v[64:65]
    v_pk_mul_f32 v[194:195], v[194:195], v[66:67]
    v_pk_mul_f32 v[196:197], v[196:197], v[68:69]
    v_pk_mul_f32 v[198:199], v[198:199], v[70:71]
    v_pk_mul_f32 v[200:201], v[200:201], v[72:73]
    v_pk_mul_f32 v[202:203], v[202:203], v[74:75]
    v_pk_mul_f32 v[204:205], v[204:205], v[76:77]
    v_pk_mul_f32 v[206:207], v[206:207], v[78:79]
    v_pk_fma_f32 v[192:193], v[192:193], v[0:1], v[160:161]
    v_pk_fma_f32 v[194:195], v[194:195], v[2:3], v[162:163]
    v_pk_fma_f32 v[196:197], v[196:197], v[4:5], v[164:165]
    v_pk_fma_f32 v[198:199], v[198:199], v[6:7], v[166:167]
    v_pk_fma_f32 v[200:201], v[200:201], v[8:9], v[168:169]
    v_pk_fma_f32 v[202:203], v[202:203], v[10:11], v[170:171]
    v_pk_fma_f32 v[204:205], v[204:205], v[12:13], v[172:173]
    v_pk_fma_f32 v[206:207], v[206:207], v[14:15], v[174:175]
    v_cvt_pk_bf16_f32 v144, v192, v193
    v_cvt_pk_bf16_f32 v145, v194, v195
    v_cvt_pk_bf16_f32 v146, v196, v197
    v_cvt_pk_bf16_f32 v147, v198, v199
    v_cvt_pk_bf16_f32 v148, v200, v201
    v_cvt_pk_bf16_f32 v149, v202, v203
    v_cvt_pk_bf16_f32 v150, v204, v205
    v_cvt_pk_bf16_f32 v151, v206, v207
    ds_write_b64 v176, v[144:145] offset:0
    ds_write_b64 v176, v[146:147] offset:32
    ds_write_b64 v176, v[148:149] offset:64
    ds_write_b64 v176, v[150:151] offset:96
    ds_read_b128 v[192:195], v177 offset:0
    ds_read_b128 v[196:199], v177 offset:1152
    s_waitcnt lgkmcnt(1)
    buffer_store_dwordx4 v[192:195], v247, s[72:75], s43 offen sc0 sc1
    s_waitcnt lgkmcnt(0)
    buffer_store_dwordx4 v[196:199], v247, s[72:75], s49 offen sc0 sc1
L_end:
    s_endpgm
L_atsf_spin:
    s_mov_b32 s55, 0
L_atsf_spin2:
    buffer_load_dword v208, v242, s[44:47], 0 offen sc1
    s_add_u32 s55, s55, 1
    s_waitcnt vmcnt(0)
    s_cmp_ge_u32 s55, 0x100000
    s_cbranch_scc1 L_atsf_ok
    v_cmp_le_u32 vcc, 64, v208
    s_nop 1
    s_cmp_eq_u64 vcc, -1
    s_cbranch_scc0 L_atsf_spin2
    s_branch L_atsf_ok
L_atpe_spin:
    s_mov_b32 s55, 0
L_atpe_spin2:
    buffer_load_dword v246, v251, s[36:39], s42 offen sc1
    s_add_u32 s55, s55, 1
    s_waitcnt vmcnt(0)
    s_cmp_ge_u32 s55, 0x100000
    s_cbranch_scc1 L_atpe_ok
    v_cmp_le_u32 vcc, 1, v246
    s_nop 1
    s_cmp_eq_u64 vcc, -1
    s_cbranch_scc0 L_atpe_spin2
    s_branch L_atpe_ok
L_ffsf_spin:
    s_mov_b32 s55, 0
L_ffsf_spin2:
    buffer_load_dword v208, v242, s[44:47], 0 offen sc1
    s_add_u32 s55, s55, 1
    s_waitcnt vmcnt(0)
    s_cmp_ge_u32 s55, 0x100000
    s_cbranch_scc1 L_ffsf_ok
    v_cmp_le_u32 vcc, 64, v208
    s_nop 1
    s_cmp_eq_u64 vcc, -1
    s_cbranch_scc0 L_ffsf_spin2
    s_branch L_ffsf_ok
L_ffpe_spin:
    s_mov_b32 s55, 0
L_ffpe_spin2:
    buffer_load_dword v246, v251, s[36:39], s42 offen sc1
    s_add_u32 s55, s55, 1
    s_waitcnt vmcnt(0)
    s_cmp_ge_u32 s55, 0x100000
    s_cbranch_scc1 L_ffpe_ok
    v_cmp_le_u32 vcc, 1, v246
    s_nop 1
    s_cmp_eq_u64 vcc, -1
    s_cbranch_scc0 L_ffpe_spin2
    s_branch L_ffpe_ok
L_ps_spin:
    s_mov_b32 s55, 0
L_ps_spin2:
    buffer_load_dword v246, v250, s[36:39], s48 offen sc1
    s_add_u32 s55, s55, 1
    s_waitcnt vmcnt(0)
    s_cmp_ge_u32 s55, 0x100000
    s_cbranch_scc1 L_ps_ok
    v_cmp_le_u32 vcc, 1, v246
    s_nop 1
    s_cmp_eq_u64 vcc, -1
    s_cbranch_scc0 L_ps_spin2
    s_branch L_ps_ok
L_py_spin:
    s_mov_b32 s55, 0
L_py_spin2:
    buffer_load_dword v246, v251, s[36:39], s42 offen sc1
    s_add_u32 s55, s55, 1
    s_waitcnt vmcnt(0)
    s_cmp_ge_u32 s55, 0x100000
    s_cbranch_scc1 L_py_ok
    v_cmp_le_u32 vcc, 1, v246
    s_nop 1
    s_cmp_eq_u64 vcc, -1
    s_cbranch_scc0 L_py_spin2
    s_branch L_py_ok
.section .rodata,"a"
.p2align 6
.amdhsa_kernel recurrent_scan__sliding_local_dilated__dense_activation_gelu__prompt_kernel
  .amdhsa_next_free_vgpr 512
  .amdhsa_next_free_sgpr 102
  .amdhsa_accum_offset 256
  .amdhsa_group_segment_fixed_size 0
  .amdhsa_kernarg_size 88
  .amdhsa_user_sgpr_count 2
  .amdhsa_user_sgpr_kernarg_segment_ptr 1
  .amdhsa_system_sgpr_workgroup_id_x 1
.end_amdhsa_kernel
```
